```python
import torch

def _softmax(x, axis=-1):
    return torch.softmax(x, dim=axis)
def _gelu(x):
    return torch.nn.functional.gelu(x, approximate="tanh")
def _silu(x):
    return torch.nn.functional.silu(x)
def _sigmoid(x):
    return torch.sigmoid(x)
def _layernorm(x, axis=-1, eps=1e-5):
    m = x.mean(dim=axis, keepdim=True)
    v = x.var(dim=axis, keepdim=True, unbiased=False)
    return (x - m) / torch.sqrt(v + eps)
def _scatter_add(tgt, idx, src, axis=0):
    return tgt.clone().index_add_(axis, idx, src)
def _segment_sum(src, seg, n):
    out = torch.zeros((n,) + src.shape[1:], dtype=src.dtype)
    return out.index_add_(0, seg, src)
def _pad(x, pw):
    flat = tuple(v for pair in reversed(pw) for v in pair)
    return torch.nn.functional.pad(x, flat)

kernel_name = 'sequential_preLN__gqa_block_cached__mixer_token_mlp__decode'

def setup_inputs():

    _w = (lambda a: (lambda t: t.to(torch.bfloat16) if t.is_floating_point() else t)(torch.as_tensor(a)))
    def _A_setup():
        B, Sq, D = 8, 1, 512
        Hq, Hkv, Sk, Dh = 32, 8, 8192, 128
        assert Hq % Hkv == 0, (Hq, Hkv)
        return {
            "x": _w((lambda *s: torch.randn(*s, dtype=torch.bfloat16) * 0.05)(B, Sq, D)),
            "k_cache": _w((lambda *s: torch.randn(*s, dtype=torch.bfloat16) * 1.6)(B, Hkv, Sk, Dh)),
            "v_cache": _w((lambda *s: torch.randn(*s, dtype=torch.bfloat16) * 0.8)(B, Hkv, Sk, Dh)),
            "wq": _w((lambda *s: torch.randn(*s, dtype=torch.bfloat16) * 1.6)(D, Hq * Dh) * (D ** -0.5)),
            "wo": _w((lambda *s: torch.randn(*s, dtype=torch.bfloat16) * 0.8)(Hq * Dh, D) * ((Hq * Dh) ** -0.5)),
        }
    _A_in = _A_setup()

    def _B_setup():
        B, S, D, F = 8, 1, 512, 1792
        return {
            "x": _w((lambda *s: torch.randn(*s, dtype=torch.bfloat16) * 0.05)(B, S, D)),
            "w1": _w((lambda *s: torch.randn(*s, dtype=torch.bfloat16) * 1.6)(S, F) * (S ** -0.5)),
            "b1": _w((lambda *s: torch.randn(*s, dtype=torch.bfloat16) * 1.6)(F) * 0.02),
            "w2": _w((lambda *s: torch.randn(*s, dtype=torch.bfloat16) * 1.6)(F, S) * (F ** -0.5)),
            "b2": _w((lambda *s: torch.randn(*s, dtype=torch.bfloat16) * 0.8)(S) * 0.02),
        }
    _B_in = _B_setup()

    return {
        "A_x": _A_in["x"],
        "A_k_cache": _A_in["k_cache"],
        "A_v_cache": _A_in["v_cache"],
        "A_wq": _A_in["wq"],
        "A_wo": _A_in["wo"],
        "B_x": _B_in["x"],
        "B_w1": _B_in["w1"],
        "B_b1": _B_in["b1"],
        "B_w2": _B_in["w2"],
        "B_b2": _B_in["b2"],
    }

def reference(A_x, A_k_cache, A_v_cache, A_wq, A_wo, B_x, B_w1, B_b1, B_w2, B_b2):
    def _A_ref(x, k_cache, v_cache, wq, wo):
        B, Sq, D = x.shape
        Hq, Dh = 32, 128
        Hkv = k_cache.shape[1]
        rep = Hq // Hkv
        q = (lambda x, *d: x.permute(*d))((x @ wq).reshape(B, Sq, Hq, Dh), 0, 2, 1, 3)
        k = (lambda x, n, axis: torch.repeat_interleave(x, n, dim=axis))(k_cache, rep, axis=1)
        v = (lambda x, n, axis: torch.repeat_interleave(x, n, dim=axis))(v_cache, rep, axis=1)
        scores = torch.einsum("bhqd,bhkd->bhqk", q, k) * (Dh ** -0.5)
        p = _softmax(scores, axis=-1)
        o = torch.einsum("bhqk,bhkd->bhqd", p, v)
        return (lambda x, *d: x.permute(*d))(o, 0, 2, 1, 3).reshape(B, Sq, Hq * Dh) @ wo

    def _B_ref(x, w1, b1, w2, b2):
        B, S, D = x.shape
        h = _layernorm(x, axis=-1)
        u = torch.einsum("bsd,sf->bdf", h, w1) + b1
        u = _gelu(u)
        y = torch.einsum("bdf,fs->bds", u, w2) + b2
        return (lambda x, *d: x.permute(*d))(y, 0, 2, 1)

    x = A_x
    h = x + _A_ref(_layernorm(x, axis=-1), A_k_cache, A_v_cache, A_wq, A_wo)
    h2 = h + _B_ref(_layernorm(h, axis=-1), B_w1, B_b1, B_w2, B_b2)
    return h2
```

```asm
; @launch grid=(256,1,1) block=(512,1,1) lds=162832
.amdgcn_target "amdgcn-amd-amdhsa--gfx950"
.text
.globl sequential_preLN__gqa_block_cached__mixer_token_mlp__decode_kernel
.p2align 8
.type sequential_preLN__gqa_block_cached__mixer_token_mlp__decode_kernel,@function
sequential_preLN__gqa_block_cached__mixer_token_mlp__decode_kernel:
    s_cmp_ge_u32 s2, 256
    s_cbranch_scc1 L_done
    s_load_dwordx16 s[80:95], s[0:1], 0
    s_load_dwordx8 s[4:11], s[0:1], 64
    s_load_dwordx2 s[96:97], s[0:1], 96
    v_lshrrev_b32 v1, 6, v0
    v_and_b32 v2, 63, v0
    s_nop 0
    v_readfirstlane_b32 s24, v1
    s_and_b32 s25, s2, 7
    s_lshr_b32 s26, s2, 5
    s_bfe_u32 s27, s2, 0x20003
    v_lshrrev_b32 v3, 4, v2
    v_and_b32 v4, 15, v2
    s_and_b32 s28, s24, 3
    s_waitcnt lgkmcnt(0)
    s_mov_b32 s76, s10
    s_and_b32 s77, s11, 0xffff
    s_mov_b32 s78, 256
    s_mov_b32 s79, 0x00020000
    s_or_b32 s30, s2, s24
    s_cmp_lg_u32 s30, 0
    s_cbranch_scc1 L_notag
    v_mov_b32 v7, 0
    s_memrealtime s[98:99]
    s_waitcnt lgkmcnt(0)
    s_or_b32 s98, s98, 1
    v_mov_b32 v6, s98
    s_mov_b64 exec, 1
    buffer_store_dword v6, v7, s[76:79], 0 offen sc1
    s_mov_b64 exec, -1
L_notag:
    s_mov_b32 s48, s86
    s_and_b32 s49, s87, 0xffff
    s_mov_b32 s50, 4194304
    s_mov_b32 s51, 0x00020000
    s_mov_b32 s44, s80
    s_and_b32 s45, s81, 0xffff
    s_mov_b32 s46, 8192
    s_mov_b32 s47, 0x00020000
    s_lshr_b32 s30, s2, 3
    s_cmp_lg_u32 s24, 0
    s_cbranch_scc1 L_nodma
    s_lshl_b32 s31, s25, 10
    s_lshl_b32 s33, s30, 5
    s_add_u32 s33, s33, s31
    v_lshrrev_b32 v6, 1, v2
    v_lshlrev_b32 v6, 13, v6
    v_and_b32 v7, 1, v2
    v_lshl_add_u32 v6, v7, 4, v6
    s_mov_b32 m0, 140288
    s_nop 0
    buffer_load_dwordx4 v6, s[48:51], s33 offen lds
    s_add_u32 s33, s33, 262144
    s_mov_b32 m0, 141312
    s_nop 0
    buffer_load_dwordx4 v6, s[48:51], s33 offen lds
    s_add_u32 s33, s33, 262144
    s_mov_b32 m0, 142336
    s_nop 0
    buffer_load_dwordx4 v6, s[48:51], s33 offen lds
    s_add_u32 s33, s33, 262144
    s_mov_b32 m0, 143360
    s_nop 0
    buffer_load_dwordx4 v6, s[48:51], s33 offen lds
    s_add_u32 s33, s33, 262144
    s_mov_b32 m0, 144384
    s_nop 0
    buffer_load_dwordx4 v6, s[48:51], s33 offen lds
    s_add_u32 s33, s33, 262144
    s_mov_b32 m0, 145408
    s_nop 0
    buffer_load_dwordx4 v6, s[48:51], s33 offen lds
    s_add_u32 s33, s33, 262144
    s_mov_b32 m0, 146432
    s_nop 0
    buffer_load_dwordx4 v6, s[48:51], s33 offen lds
    s_add_u32 s33, s33, 262144
    s_mov_b32 m0, 147456
    s_nop 0
    buffer_load_dwordx4 v6, s[48:51], s33 offen lds
    s_add_u32 s33, s33, 262144
    s_mov_b32 m0, 148480
    s_nop 0
    buffer_load_dwordx4 v6, s[48:51], s33 offen lds
    s_add_u32 s33, s33, 262144
    s_mov_b32 m0, 149504
    s_nop 0
    buffer_load_dwordx4 v6, s[48:51], s33 offen lds
    s_add_u32 s33, s33, 262144
    s_mov_b32 m0, 150528
    s_nop 0
    buffer_load_dwordx4 v6, s[48:51], s33 offen lds
    s_add_u32 s33, s33, 262144
    s_mov_b32 m0, 151552
    s_nop 0
    buffer_load_dwordx4 v6, s[48:51], s33 offen lds
    s_add_u32 s33, s33, 262144
    s_mov_b32 m0, 152576
    s_nop 0
    buffer_load_dwordx4 v6, s[48:51], s33 offen lds
    s_add_u32 s33, s33, 262144
    s_mov_b32 m0, 153600
    s_nop 0
    buffer_load_dwordx4 v6, s[48:51], s33 offen lds
    s_add_u32 s33, s33, 262144
    s_mov_b32 m0, 154624
    s_nop 0
    buffer_load_dwordx4 v6, s[48:51], s33 offen lds
    s_add_u32 s33, s33, 262144
    s_mov_b32 m0, 155648
    s_nop 0
    buffer_load_dwordx4 v6, s[48:51], s33 offen lds
    s_add_u32 s33, s33, 262144
L_nodma:
    s_lshl_b32 s29, s24, 10
    v_lshlrev_b32 v5, 4, v2
    buffer_load_dwordx4 v[192:195], v5, s[44:47], s29 offen
    s_mov_b32 s12, s82
    s_and_b32 s13, s83, 0xffff
    s_mov_b32 s14, 134217728
    s_mov_b32 s15, 0x00020000
    s_mov_b32 s16, s84
    s_and_b32 s17, s85, 0xffff
    s_mov_b32 s18, 134217728
    s_mov_b32 s19, 0x00020000
    s_mov_b32 s20, s96
    s_and_b32 s21, s97, 0xffff
    s_mov_b32 s22, 4194304
    s_mov_b32 s23, 0x00020000
    s_mov_b32 s52, s88
    s_and_b32 s53, s89, 0xffff
    s_mov_b32 s54, 4194304
    s_mov_b32 s55, 0x00020000
    s_mov_b32 s56, s92
    s_and_b32 s57, s93, 0xffff
    s_mov_b32 s58, 3584
    s_mov_b32 s59, 0x00020000
    s_mov_b32 s60, s94
    s_and_b32 s61, s95, 0xffff
    s_mov_b32 s62, 3584
    s_mov_b32 s63, 0x00020000
    s_mov_b32 s64, s4
    s_and_b32 s65, s5, 0xffff
    s_mov_b32 s66, 3584
    s_mov_b32 s67, 0x00020000
    s_mov_b32 s68, s6
    s_and_b32 s69, s7, 0xffff
    s_mov_b32 s70, 2
    s_mov_b32 s71, 0x00020000
    s_mov_b32 s72, s8
    s_and_b32 s73, s9, 0xffff
    s_mov_b32 s74, 8192
    s_mov_b32 s75, 0x00020000
    s_lshl_b32 s31, s26, 3
    s_add_u32 s31, s31, s25
    s_lshl_b32 s29, s31, 21
    s_lshl_b32 s31, s27, 19
    s_add_u32 s29, s29, s31
    s_lshl_b32 s31, s24, 12
    s_add_u32 s29, s29, s31
    s_mov_b32 s40, s29
    s_lshl_b32 s31, s24, 14

    v_add_u32 v5, 0, v3
    v_xor_b32 v5, v5, v4
    v_lshlrev_b32 v5, 4, v5
    v_lshl_add_u32 v10, v3, 8, v5
    v_add_u32 v5, 4, v3
    v_xor_b32 v5, v5, v4
    v_lshlrev_b32 v5, 4, v5
    v_lshl_add_u32 v11, v3, 8, v5
    v_add_u32 v5, 8, v3
    v_xor_b32 v5, v5, v4
    v_lshlrev_b32 v5, 4, v5
    v_lshl_add_u32 v12, v3, 8, v5
    v_add_u32 v5, 12, v3
    v_xor_b32 v5, v5, v4
    v_lshlrev_b32 v5, 4, v5
    v_lshl_add_u32 v13, v3, 8, v5
    v_add_u32 v5, 0, v3
    v_lshlrev_b32 v5, 1, v5
    v_xor_b32 v5, v5, v4
    v_lshlrev_b32 v5, 4, v5
    v_lshl_add_u32 v14, v3, 8, v5
    v_add_u32 v5, 4, v3
    v_lshlrev_b32 v5, 1, v5
    v_xor_b32 v5, v5, v4
    v_lshlrev_b32 v5, 4, v5
    v_lshl_add_u32 v15, v3, 8, v5
    s_add_u32 m0, s31, 0
    s_nop 0
    buffer_load_dwordx4 v10, s[12:15], s29 offen offset:0 nt lds
    buffer_load_dwordx4 v11, s[12:15], s29 offen offset:1024 nt lds
    buffer_load_dwordx4 v12, s[12:15], s29 offen offset:2048 nt lds
    buffer_load_dwordx4 v13, s[12:15], s29 offen offset:3072 nt lds
    s_add_u32 s29, s29, 32768
    v_xor_b32 v5, v3, v4
    v_lshlrev_b32 v5, 4, v5
    v_lshl_add_u32 v5, v4, 8, v5
    v_add_u32 v5, s31, v5
    v_xor_b32 v16, 0, v5
    v_xor_b32 v17, 64, v5
    v_xor_b32 v18, 128, v5
    v_xor_b32 v19, 192, v5
    v_lshrrev_b32 v5, 2, v4
    v_lshl_add_u32 v5, v3, 2, v5
    v_and_b32 v6, 7, v5
    v_lshlrev_b32 v6, 5, v6
    v_lshl_add_u32 v6, v5, 8, v6
    v_and_b32 v7, 3, v4
    v_lshl_add_u32 v6, v7, 3, v6
    v_add_u32 v6, s31, v6
    v_xor_b32 v20, 0, v6
    v_xor_b32 v21, 32, v6
    v_xor_b32 v22, 64, v6
    v_xor_b32 v23, 96, v6
    v_xor_b32 v24, 128, v6
    v_xor_b32 v25, 160, v6
    v_xor_b32 v26, 192, v6
    v_xor_b32 v27, 224, v6
    s_mov_b32 s34, 0x3fb8aa3b
    s_mov_b32 s38, 0x05040100
    s_mov_b32 s39, 0x07060302
    s_waitcnt vmcnt(4)
    v_lshlrev_b32 v200, 16, v192
    v_and_b32 v201, 0xffff0000, v192
    v_lshlrev_b32 v202, 16, v193
    v_and_b32 v203, 0xffff0000, v193
    v_lshlrev_b32 v204, 16, v194
    v_and_b32 v205, 0xffff0000, v194
    v_lshlrev_b32 v206, 16, v195
    v_and_b32 v207, 0xffff0000, v195
    v_add_f32 v208, v200, v201
    v_add_f32 v208, v208, v202
    v_add_f32 v208, v208, v203
    v_add_f32 v208, v208, v204
    v_add_f32 v208, v208, v205
    v_add_f32 v208, v208, v206
    v_add_f32 v208, v208, v207
    s_nop 1
    v_add_f32_dpp v208, v208, v208 quad_perm:[1,0,3,2] row_mask:0xf bank_mask:0xf
    s_nop 1
    v_add_f32_dpp v208, v208, v208 quad_perm:[2,3,0,1] row_mask:0xf bank_mask:0xf
    s_nop 1
    v_add_f32_dpp v208, v208, v208 row_half_mirror row_mask:0xf bank_mask:0xf
    s_nop 1
    v_add_f32_dpp v208, v208, v208 row_mirror row_mask:0xf bank_mask:0xf
    v_mov_b32 v209, v208
    s_nop 1
    v_permlane16_swap_b32 v208, v209
    s_nop 0
    v_add_f32 v208, v208, v209
    v_mov_b32 v209, v208
    s_nop 1
    v_permlane32_swap_b32 v208, v209
    s_nop 0
    v_add_f32 v208, v208, v209
    v_mul_f32 v208, 0x3b000000, v208
    v_sub_f32 v209, v200, v208
    v_mul_f32 v210, v209, v209
    v_sub_f32 v209, v201, v208
    v_fmac_f32 v210, v209, v209
    v_sub_f32 v209, v202, v208
    v_fmac_f32 v210, v209, v209
    v_sub_f32 v209, v203, v208
    v_fmac_f32 v210, v209, v209
    v_sub_f32 v209, v204, v208
    v_fmac_f32 v210, v209, v209
    v_sub_f32 v209, v205, v208
    v_fmac_f32 v210, v209, v209
    v_sub_f32 v209, v206, v208
    v_fmac_f32 v210, v209, v209
    v_sub_f32 v209, v207, v208
    v_fmac_f32 v210, v209, v209
    s_nop 1
    v_add_f32_dpp v210, v210, v210 quad_perm:[1,0,3,2] row_mask:0xf bank_mask:0xf
    s_nop 1
    v_add_f32_dpp v210, v210, v210 quad_perm:[2,3,0,1] row_mask:0xf bank_mask:0xf
    s_nop 1
    v_add_f32_dpp v210, v210, v210 row_half_mirror row_mask:0xf bank_mask:0xf
    s_nop 1
    v_add_f32_dpp v210, v210, v210 row_mirror row_mask:0xf bank_mask:0xf
    v_mov_b32 v209, v210
    s_nop 1
    v_permlane16_swap_b32 v210, v209
    s_nop 0
    v_add_f32 v210, v210, v209
    v_mov_b32 v209, v210
    s_nop 1
    v_permlane32_swap_b32 v210, v209
    s_nop 0
    v_add_f32 v210, v210, v209
    v_mul_f32 v210, 0x3b000000, v210
    v_cvt_pk_bf16_f32 v209, v208, v210
    v_lshlrev_b32 v208, 16, v209
    v_and_b32 v210, 0xffff0000, v209
    v_add_f32 v210, 0x3727c5ac, v210
    v_cvt_pk_bf16_f32 v210, v210, v210
    v_lshlrev_b32 v210, 16, v210
    v_sqrt_f32 v210, v210
    s_nop 0
    v_cvt_pk_bf16_f32 v210, v210, v210
    v_lshlrev_b32 v210, 16, v210
    v_rcp_f32 v210, v210
    v_sub_f32 v200, v200, v208
    v_sub_f32 v201, v201, v208
    v_sub_f32 v202, v202, v208
    v_sub_f32 v203, v203, v208
    v_sub_f32 v204, v204, v208
    v_sub_f32 v205, v205, v208
    v_sub_f32 v206, v206, v208
    v_sub_f32 v207, v207, v208
    v_cvt_pk_bf16_f32 v209, v200, v201
    v_lshlrev_b32 v200, 16, v209
    v_and_b32 v201, 0xffff0000, v209
    v_cvt_pk_bf16_f32 v209, v202, v203
    v_lshlrev_b32 v202, 16, v209
    v_and_b32 v203, 0xffff0000, v209
    v_cvt_pk_bf16_f32 v209, v204, v205
    v_lshlrev_b32 v204, 16, v209
    v_and_b32 v205, 0xffff0000, v209
    v_cvt_pk_bf16_f32 v209, v206, v207
    v_lshlrev_b32 v206, 16, v209
    v_and_b32 v207, 0xffff0000, v209
    v_mul_f32 v200, v200, v210
    v_mul_f32 v201, v201, v210
    v_mul_f32 v202, v202, v210
    v_mul_f32 v203, v203, v210
    v_mul_f32 v204, v204, v210
    v_mul_f32 v205, v205, v210
    v_mul_f32 v206, v206, v210
    v_mul_f32 v207, v207, v210
    v_cvt_pk_bf16_f32 v209, v200, v201
    v_lshlrev_b32 v200, 16, v209
    v_and_b32 v201, 0xffff0000, v209
    v_cvt_pk_bf16_f32 v209, v202, v203
    v_lshlrev_b32 v202, 16, v209
    v_and_b32 v203, 0xffff0000, v209
    v_cvt_pk_bf16_f32 v209, v204, v205
    v_lshlrev_b32 v204, 16, v209
    v_and_b32 v205, 0xffff0000, v209
    v_cvt_pk_bf16_f32 v209, v206, v207
    v_lshlrev_b32 v206, 16, v209
    v_and_b32 v207, 0xffff0000, v209
    v_cvt_pk_bf16_f32 v192, v200, v201
    v_cvt_pk_bf16_f32 v193, v202, v203
    v_cvt_pk_bf16_f32 v194, v204, v205
    v_cvt_pk_bf16_f32 v195, v206, v207
    s_lshl_b32 s32, s24, 10
    s_add_u32 s32, s32, 132096
    v_lshl_add_u32 v5, v2, 4, s32
    ds_write_b128 v5, v[192:195]
    s_cmp_lg_u32 s24, 1
    s_cbranch_scc1 L_b1
    v_mov_b32 v7, 0
    s_mov_b32 s33, 0
L_ptag:
    buffer_load_dword v6, v7, s[76:79], 0 offen sc1
    s_waitcnt vmcnt(0)
    v_readfirstlane_b32 s32, v6
    s_cmp_lg_u32 s32, 0
    s_cbranch_scc1 L_ptag_ok
    s_sleep 1
    s_add_u32 s33, s33, 1
    s_cmp_lt_u32 s33, 1000000
    s_cbranch_scc1 L_ptag
L_ptag_ok:
    v_mov_b32 v7, 162816
    ds_write_b32 v7, v6
L_b1:
    s_waitcnt lgkmcnt(0)
    s_barrier
    v_mov_b32 v7, 162816
    ds_read_b32 v6, v7
    s_waitcnt lgkmcnt(0)
    v_readfirstlane_b32 s43, v6
    s_cmp_lg_u32 s24, 0
    s_cbranch_scc1 L_noq
    v_lshrrev_b32 v5, 2, v4
    v_lshl_add_u32 v5, v3, 3, v5
    v_lshlrev_b32 v5, 5, v5
    v_and_b32 v6, 3, v4
    v_lshl_add_u32 v5, v6, 3, v5
    v_add_u32 v5, 140288, v5
    v_and_b32 v6, 7, v4
    v_lshlrev_b32 v6, 10, v6
    v_lshl_add_u32 v6, v3, 4, v6
    v_add_u32 v6, 132096, v6
    ds_read_b64_tr_b16 v[192:193], v5 offset:0
    ds_read_b64_tr_b16 v[194:195], v5 offset:128
    ds_read_b128 v[196:199], v6 offset:0
    ds_read_b64_tr_b16 v[200:201], v5 offset:1024
    ds_read_b64_tr_b16 v[202:203], v5 offset:1152
    ds_read_b128 v[204:207], v6 offset:64
    ds_read_b64_tr_b16 v[208:209], v5 offset:2048
    ds_read_b64_tr_b16 v[210:211], v5 offset:2176
    ds_read_b128 v[212:215], v6 offset:128
    s_waitcnt lgkmcnt(6)
    v_mfma_f32_16x16x32_bf16 v[216:219], v[192:195], v[196:199], 0
    ds_read_b64_tr_b16 v[192:193], v5 offset:3072
    ds_read_b64_tr_b16 v[194:195], v5 offset:3200
    ds_read_b128 v[196:199], v6 offset:192
    s_waitcnt lgkmcnt(6)
    v_mfma_f32_16x16x32_bf16 v[216:219], v[200:203], v[204:207], v[216:219]
    ds_read_b64_tr_b16 v[200:201], v5 offset:4096
    ds_read_b64_tr_b16 v[202:203], v5 offset:4224
    ds_read_b128 v[204:207], v6 offset:256
    s_waitcnt lgkmcnt(6)
    v_mfma_f32_16x16x32_bf16 v[216:219], v[208:211], v[212:215], v[216:219]
    ds_read_b64_tr_b16 v[208:209], v5 offset:5120
    ds_read_b64_tr_b16 v[210:211], v5 offset:5248
    ds_read_b128 v[212:215], v6 offset:320
    s_waitcnt lgkmcnt(6)
    v_mfma_f32_16x16x32_bf16 v[216:219], v[192:195], v[196:199], v[216:219]
    ds_read_b64_tr_b16 v[192:193], v5 offset:6144
    ds_read_b64_tr_b16 v[194:195], v5 offset:6272
    ds_read_b128 v[196:199], v6 offset:384
    s_waitcnt lgkmcnt(6)
    v_mfma_f32_16x16x32_bf16 v[216:219], v[200:203], v[204:207], v[216:219]
    ds_read_b64_tr_b16 v[200:201], v5 offset:7168
    ds_read_b64_tr_b16 v[202:203], v5 offset:7296
    ds_read_b128 v[204:207], v6 offset:448
    s_waitcnt lgkmcnt(6)
    v_mfma_f32_16x16x32_bf16 v[216:219], v[208:211], v[212:215], v[216:219]
    ds_read_b64_tr_b16 v[208:209], v5 offset:8192
    ds_read_b64_tr_b16 v[210:211], v5 offset:8320
    ds_read_b128 v[212:215], v6 offset:512
    s_waitcnt lgkmcnt(6)
    v_mfma_f32_16x16x32_bf16 v[216:219], v[192:195], v[196:199], v[216:219]
    ds_read_b64_tr_b16 v[192:193], v5 offset:9216
    ds_read_b64_tr_b16 v[194:195], v5 offset:9344
    ds_read_b128 v[196:199], v6 offset:576
    s_waitcnt lgkmcnt(6)
    v_mfma_f32_16x16x32_bf16 v[216:219], v[200:203], v[204:207], v[216:219]
    ds_read_b64_tr_b16 v[200:201], v5 offset:10240
    ds_read_b64_tr_b16 v[202:203], v5 offset:10368
    ds_read_b128 v[204:207], v6 offset:640
    s_waitcnt lgkmcnt(6)
    v_mfma_f32_16x16x32_bf16 v[216:219], v[208:211], v[212:215], v[216:219]
    ds_read_b64_tr_b16 v[208:209], v5 offset:11264
    ds_read_b64_tr_b16 v[210:211], v5 offset:11392
    ds_read_b128 v[212:215], v6 offset:704
    s_waitcnt lgkmcnt(6)
    v_mfma_f32_16x16x32_bf16 v[216:219], v[192:195], v[196:199], v[216:219]
    ds_read_b64_tr_b16 v[192:193], v5 offset:12288
    ds_read_b64_tr_b16 v[194:195], v5 offset:12416
    ds_read_b128 v[196:199], v6 offset:768
    s_waitcnt lgkmcnt(6)
    v_mfma_f32_16x16x32_bf16 v[216:219], v[200:203], v[204:207], v[216:219]
    ds_read_b64_tr_b16 v[200:201], v5 offset:13312
    ds_read_b64_tr_b16 v[202:203], v5 offset:13440
    ds_read_b128 v[204:207], v6 offset:832
    s_waitcnt lgkmcnt(6)
    v_mfma_f32_16x16x32_bf16 v[216:219], v[208:211], v[212:215], v[216:219]
    ds_read_b64_tr_b16 v[208:209], v5 offset:14336
    ds_read_b64_tr_b16 v[210:211], v5 offset:14464
    ds_read_b128 v[212:215], v6 offset:896
    s_waitcnt lgkmcnt(6)
    v_mfma_f32_16x16x32_bf16 v[216:219], v[192:195], v[196:199], v[216:219]
    ds_read_b64_tr_b16 v[192:193], v5 offset:15360
    ds_read_b64_tr_b16 v[194:195], v5 offset:15488
    ds_read_b128 v[196:199], v6 offset:960
    s_waitcnt lgkmcnt(6)
    v_mfma_f32_16x16x32_bf16 v[216:219], v[200:203], v[204:207], v[216:219]
    s_waitcnt lgkmcnt(3)
    v_mfma_f32_16x16x32_bf16 v[216:219], v[208:211], v[212:215], v[216:219]
    s_waitcnt lgkmcnt(0)
    v_mfma_f32_16x16x32_bf16 v[216:219], v[192:195], v[196:199], v[216:219]
    v_mov_b32 v221, s43
    v_mov_b32 v223, s43
    v_lshlrev_b32 v5, 14, v4
    v_lshl_add_u32 v5, v3, 4, v5
    s_lshl_b32 s32, s25, 11
    s_lshl_b32 s33, s30, 6
    s_add_u32 s32, s32, s33
    s_add_u32 s32, s32, 0
    v_cmp_gt_u32 vcc, 8, v4
    s_nop 3
    v_cvt_pk_bf16_f32 v220, v216, v217
    v_cvt_pk_bf16_f32 v222, v218, v219
    s_and_saveexec_b64 s[36:37], vcc
    buffer_store_dwordx4 v[220:223], v5, s[20:23], s32 offen sc1
    s_mov_b64 exec, s[36:37]
L_noq:
    s_barrier
    s_add_u32 m0, s31, 8192
    s_nop 0
    buffer_load_dwordx4 v14, s[16:19], s40 offen offset:0 nt lds
    buffer_load_dwordx4 v15, s[16:19], s40 offen offset:1024 nt lds
    buffer_load_dwordx4 v14, s[16:19], s40 offen offset:2048 nt lds
    buffer_load_dwordx4 v15, s[16:19], s40 offen offset:3072 nt lds
    s_add_u32 s40, s40, 32768
    s_add_u32 m0, s31, 4096
    s_nop 0
    buffer_load_dwordx4 v10, s[12:15], s29 offen offset:0 nt lds
    buffer_load_dwordx4 v11, s[12:15], s29 offen offset:1024 nt lds
    buffer_load_dwordx4 v12, s[12:15], s29 offen offset:2048 nt lds
    buffer_load_dwordx4 v13, s[12:15], s29 offen offset:3072 nt lds
    s_add_u32 s29, s29, 32768
    s_barrier
    s_cmp_lg_u32 s24, 0
    s_cbranch_scc1 L_rest
    s_lshl_b32 s32, s26, 14
    s_lshl_b32 s33, s25, 11
    s_add_u32 s32, s32, s33
    s_add_u32 s32, s32, 0
    v_lshlrev_b32 v5, 5, v2
    s_mov_b32 s33, 0
L_pollq:
    buffer_load_dwordx4 v[192:195], v5, s[20:23], s32 offen sc1
    buffer_load_dwordx4 v[196:199], v5, s[20:23], s32 offen offset:16 sc1
    s_waitcnt vmcnt(0)
    v_xor_b32 v6, s43, v193
    v_xor_b32 v7, s43, v195
    v_or_b32 v6, v6, v7
    v_xor_b32 v7, s43, v197
    v_or_b32 v6, v6, v7
    v_xor_b32 v7, s43, v199
    v_or_b32 v6, v6, v7
    v_cmp_ne_u32 vcc, 0, v6
    s_cmp_eq_u64 vcc, 0
    s_cbranch_scc1 L_pollq_ok
    s_sleep 1
    s_add_u32 s33, s33, 1
    s_cmp_lt_u32 s33, 1000000
    s_cbranch_scc1 L_pollq
L_pollq_ok:
    v_mov_b32 v193, v194
    v_mov_b32 v194, v196
    v_mov_b32 v195, v198
    v_lshlrev_b32 v5, 4, v2
    v_add_u32 v5, 131072, v5
    ds_write_b128 v5, v[192:195]
L_rest:
    s_add_u32 m0, s31, 12288
    s_nop 0
    buffer_load_dwordx4 v14, s[16:19], s40 offen offset:0 nt lds
    buffer_load_dwordx4 v15, s[16:19], s40 offen offset:1024 nt lds
    buffer_load_dwordx4 v14, s[16:19], s40 offen offset:2048 nt lds
    buffer_load_dwordx4 v15, s[16:19], s40 offen offset:3072 nt lds
    s_add_u32 s40, s40, 32768
    v_mov_b32 v86, 0xff800000
    v_mov_b32 v87, 0
    v_mov_b32 v96, 0
    v_mov_b32 v97, 0
    v_mov_b32 v98, 0
    v_mov_b32 v99, 0
    v_mov_b32 v100, 0
    v_mov_b32 v101, 0
    v_mov_b32 v102, 0
    v_mov_b32 v103, 0
    v_mov_b32 v104, 0
    v_mov_b32 v105, 0
    v_mov_b32 v106, 0
    v_mov_b32 v107, 0
    v_mov_b32 v108, 0
    v_mov_b32 v109, 0
    v_mov_b32 v110, 0
    v_mov_b32 v111, 0
    v_mov_b32 v112, 0
    v_mov_b32 v113, 0
    v_mov_b32 v114, 0
    v_mov_b32 v115, 0
    v_mov_b32 v116, 0
    v_mov_b32 v117, 0
    v_mov_b32 v118, 0
    v_mov_b32 v119, 0
    v_mov_b32 v120, 0
    v_mov_b32 v121, 0
    v_mov_b32 v122, 0
    v_mov_b32 v123, 0
    v_mov_b32 v124, 0
    v_mov_b32 v125, 0
    v_mov_b32 v126, 0
    v_mov_b32 v127, 0
    v_and_b32 v5, 3, v4
    v_lshlrev_b32 v5, 8, v5
    v_lshl_add_u32 v5, v3, 4, v5
    v_add_u32 v5, 131072, v5
    s_waitcnt lgkmcnt(0)
    s_barrier
    ds_read_b128 v[32:35], v5 offset:0
    ds_read_b128 v[36:39], v5 offset:64
    ds_read_b128 v[40:43], v5 offset:128
    ds_read_b128 v[44:47], v5 offset:192
    s_waitcnt lgkmcnt(0)
    v_lshlrev_b32 v5, 13, v3
    v_lshl_add_u32 v5, v4, 4, v5
    s_lshl_b32 s35, s25, 2
    s_add_u32 s35, s35, s28
    s_lshl_b32 s35, s35, 17
    s_lshr_b32 s32, s24, 2
    s_lshl_b32 s32, s32, 16
    s_add_u32 s35, s35, s32
    s_lshl_b32 s32, s27, 8
    s_add_u32 s35, s35, s32
    s_add_u32 s32, s35, 0
    buffer_load_dwordx4 v[128:131], v5, s[52:55], s32 offen
    s_add_u32 s32, s35, 1024
    buffer_load_dwordx4 v[132:135], v5, s[52:55], s32 offen
    s_add_u32 s32, s35, 2048
    buffer_load_dwordx4 v[136:139], v5, s[52:55], s32 offen
    s_add_u32 s32, s35, 3072
    buffer_load_dwordx4 v[140:143], v5, s[52:55], s32 offen
    s_add_u32 s32, s35, 4096
    buffer_load_dwordx4 v[144:147], v5, s[52:55], s32 offen
    s_add_u32 s32, s35, 5120
    buffer_load_dwordx4 v[148:151], v5, s[52:55], s32 offen
    s_add_u32 s32, s35, 6144
    buffer_load_dwordx4 v[152:155], v5, s[52:55], s32 offen
    s_add_u32 s32, s35, 7168
    buffer_load_dwordx4 v[156:159], v5, s[52:55], s32 offen
    s_add_u32 s32, s35, 32768
    buffer_load_dwordx4 v[160:163], v5, s[52:55], s32 offen
    s_add_u32 s32, s35, 33792
    buffer_load_dwordx4 v[164:167], v5, s[52:55], s32 offen
    s_add_u32 s32, s35, 34816
    buffer_load_dwordx4 v[168:171], v5, s[52:55], s32 offen
    s_add_u32 s32, s35, 35840
    buffer_load_dwordx4 v[172:175], v5, s[52:55], s32 offen
    s_add_u32 s32, s35, 36864
    buffer_load_dwordx4 v[176:179], v5, s[52:55], s32 offen
    s_add_u32 s32, s35, 37888
    buffer_load_dwordx4 v[180:183], v5, s[52:55], s32 offen
    s_add_u32 s32, s35, 38912
    buffer_load_dwordx4 v[184:187], v5, s[52:55], s32 offen
    s_add_u32 s32, s35, 39936
    buffer_load_dwordx4 v[188:191], v5, s[52:55], s32 offen
    v_and_b32 v6, 255, v0
    v_lshlrev_b32 v6, 1, v6
    buffer_load_ushort v224, v6, s[56:59], 0 offen offset:0
    buffer_load_ushort v232, v6, s[60:63], 0 offen offset:0
    buffer_load_ushort v240, v6, s[64:67], 0 offen offset:0
    buffer_load_ushort v225, v6, s[56:59], 0 offen offset:512
    buffer_load_ushort v233, v6, s[60:63], 0 offen offset:512
    buffer_load_ushort v241, v6, s[64:67], 0 offen offset:512
    buffer_load_ushort v226, v6, s[56:59], 0 offen offset:1024
    buffer_load_ushort v234, v6, s[60:63], 0 offen offset:1024
    buffer_load_ushort v242, v6, s[64:67], 0 offen offset:1024
    buffer_load_ushort v227, v6, s[56:59], 0 offen offset:1536
    buffer_load_ushort v235, v6, s[60:63], 0 offen offset:1536
    buffer_load_ushort v243, v6, s[64:67], 0 offen offset:1536
    buffer_load_ushort v228, v6, s[56:59], 0 offen offset:2048
    buffer_load_ushort v236, v6, s[60:63], 0 offen offset:2048
    buffer_load_ushort v244, v6, s[64:67], 0 offen offset:2048
    buffer_load_ushort v229, v6, s[56:59], 0 offen offset:2560
    buffer_load_ushort v237, v6, s[60:63], 0 offen offset:2560
    buffer_load_ushort v245, v6, s[64:67], 0 offen offset:2560
    buffer_load_ushort v230, v6, s[56:59], 0 offen offset:3072
    buffer_load_ushort v238, v6, s[60:63], 0 offen offset:3072
    buffer_load_ushort v246, v6, s[64:67], 0 offen offset:3072
    v_mov_b32 v7, 0
    buffer_load_ushort v254, v7, s[68:71], 0 offen
    v_lshlrev_b32 v6, 4, v2
    s_lshl_b32 s42, s26, 10
    buffer_load_dwordx4 v[250:253], v6, s[44:47], s42 offen
    s_waitcnt vmcnt(51)
    ds_read_b128 v[48:51], v16 offset:0
    ds_read_b128 v[52:55], v17 offset:0
    ds_read_b128 v[56:59], v18 offset:0
    ds_read_b128 v[60:63], v19 offset:0
    s_waitcnt lgkmcnt(0)
    v_mfma_f32_16x16x32_bf16 v[80:83], v[48:51], v[32:35], 0
    v_mfma_f32_16x16x32_bf16 v[80:83], v[52:55], v[36:39], v[80:83]
    v_mfma_f32_16x16x32_bf16 v[80:83], v[56:59], v[40:43], v[80:83]
    v_mfma_f32_16x16x32_bf16 v[80:83], v[60:63], v[44:47], v[80:83]
    s_add_u32 m0, s31, 0
    s_nop 0
    buffer_load_dwordx4 v10, s[12:15], s29 offen offset:0 nt lds
    buffer_load_dwordx4 v11, s[12:15], s29 offen offset:1024 nt lds
    buffer_load_dwordx4 v12, s[12:15], s29 offen offset:2048 nt lds
    buffer_load_dwordx4 v13, s[12:15], s29 offen offset:3072 nt lds
    s_add_u32 s29, s29, 32768
    s_nop 1
    v_cvt_pk_bf16_f32 v29, v80, v81
    v_lshlrev_b32 v80, 16, v29
    v_and_b32 v81, 0xffff0000, v29
    v_cvt_pk_bf16_f32 v29, v82, v83
    v_lshlrev_b32 v82, 16, v29
    v_and_b32 v83, 0xffff0000, v29
    v_mul_f32 v80, 0x3db504f3, v80
    v_mul_f32 v81, 0x3db504f3, v81
    v_mul_f32 v82, 0x3db504f3, v82
    v_mul_f32 v83, 0x3db504f3, v83
    v_cvt_pk_bf16_f32 v29, v80, v81
    v_lshlrev_b32 v80, 16, v29
    v_and_b32 v81, 0xffff0000, v29
    v_cvt_pk_bf16_f32 v29, v82, v83
    v_lshlrev_b32 v82, 16, v29
    v_and_b32 v83, 0xffff0000, v29
    v_max3_f32 v28, v80, v81, v82
    v_max_f32 v28, v28, v83
    v_mov_b32 v29, v28
    s_nop 1
    v_permlane16_swap_b32 v28, v29
    s_nop 0
    v_max_f32 v28, v28, v29
    v_mov_b32 v29, v28
    s_nop 1
    v_permlane32_swap_b32 v28, v29
    s_nop 0
    v_max_f32 v28, v28, v29
    v_max_f32 v28, v28, v86
    v_sub_f32 v29, v86, v28
    v_mul_f32 v29, 0x3fb8aa3b, v29
    v_exp_f32 v30, v29
    v_mul_f32 v31, 0xbfb8aa3b, v28
    v_mov_b32 v86, v28
    v_fma_f32 v80, v80, s34, v31
    v_fma_f32 v81, v81, s34, v31
    v_fma_f32 v82, v82, s34, v31
    v_fma_f32 v83, v83, s34, v31
    v_exp_f32 v80, v80
    v_exp_f32 v81, v81
    v_exp_f32 v82, v82
    v_exp_f32 v83, v83
    v_mul_f32 v87, v87, v30
    s_waitcnt vmcnt(51)
    ds_read_b64_tr_b16 v[64:65], v20 offset:8192
    ds_read_b64_tr_b16 v[66:67], v21 offset:8192
    ds_read_b64_tr_b16 v[68:69], v22 offset:8192
    ds_read_b64_tr_b16 v[70:71], v23 offset:8192
    ds_read_b64_tr_b16 v[72:73], v24 offset:8192
    ds_read_b64_tr_b16 v[74:75], v25 offset:8192
    ds_read_b64_tr_b16 v[76:77], v26 offset:8192
    ds_read_b64_tr_b16 v[78:79], v27 offset:8192
    v_mul_f32 v96, v96, v30
    v_mul_f32 v97, v97, v30
    v_mul_f32 v98, v98, v30
    v_mul_f32 v99, v99, v30
    v_mul_f32 v100, v100, v30
    v_mul_f32 v101, v101, v30
    v_mul_f32 v102, v102, v30
    v_mul_f32 v103, v103, v30
    v_mul_f32 v104, v104, v30
    v_mul_f32 v105, v105, v30
    v_mul_f32 v106, v106, v30
    v_mul_f32 v107, v107, v30
    v_mul_f32 v108, v108, v30
    v_mul_f32 v109, v109, v30
    v_mul_f32 v110, v110, v30
    v_mul_f32 v111, v111, v30
    v_mul_f32 v112, v112, v30
    v_mul_f32 v113, v113, v30
    v_mul_f32 v114, v114, v30
    v_mul_f32 v115, v115, v30
    v_mul_f32 v116, v116, v30
    v_mul_f32 v117, v117, v30
    v_mul_f32 v118, v118, v30
    v_mul_f32 v119, v119, v30
    v_mul_f32 v120, v120, v30
    v_mul_f32 v121, v121, v30
    v_mul_f32 v122, v122, v30
    v_mul_f32 v123, v123, v30
    v_mul_f32 v124, v124, v30
    v_mul_f32 v125, v125, v30
    v_mul_f32 v126, v126, v30
    v_mul_f32 v127, v127, v30
    v_add_f32 v87, v87, v80
    v_add_f32 v87, v87, v81
    v_add_f32 v87, v87, v82
    v_add_f32 v87, v87, v83
    v_cvt_pk_bf16_f32 v84, v80, v81
    v_cvt_pk_bf16_f32 v85, v82, v83
    s_waitcnt lgkmcnt(0)
    s_nop 1
    v_mfma_f32_16x16x16_bf16 v[96:99], v[64:65], v[84:85], v[96:99]
    v_mfma_f32_16x16x16_bf16 v[100:103], v[66:67], v[84:85], v[100:103]
    v_mfma_f32_16x16x16_bf16 v[104:107], v[68:69], v[84:85], v[104:107]
    v_mfma_f32_16x16x16_bf16 v[108:111], v[70:71], v[84:85], v[108:111]
    v_mfma_f32_16x16x16_bf16 v[112:115], v[72:73], v[84:85], v[112:115]
    v_mfma_f32_16x16x16_bf16 v[116:119], v[74:75], v[84:85], v[116:119]
    v_mfma_f32_16x16x16_bf16 v[120:123], v[76:77], v[84:85], v[120:123]
    v_mfma_f32_16x16x16_bf16 v[124:127], v[78:79], v[84:85], v[124:127]
    s_add_u32 m0, s31, 8192
    s_nop 0
    buffer_load_dwordx4 v14, s[16:19], s40 offen offset:0 nt lds
    buffer_load_dwordx4 v15, s[16:19], s40 offen offset:1024 nt lds
    buffer_load_dwordx4 v14, s[16:19], s40 offen offset:2048 nt lds
    buffer_load_dwordx4 v15, s[16:19], s40 offen offset:3072 nt lds
    s_add_u32 s40, s40, 32768
    s_waitcnt vmcnt(51)
    ds_read_b128 v[48:51], v16 offset:4096
    ds_read_b128 v[52:55], v17 offset:4096
    ds_read_b128 v[56:59], v18 offset:4096
    ds_read_b128 v[60:63], v19 offset:4096
    s_waitcnt lgkmcnt(0)
    v_mfma_f32_16x16x32_bf16 v[80:83], v[48:51], v[32:35], 0
    v_mfma_f32_16x16x32_bf16 v[80:83], v[52:55], v[36:39], v[80:83]
    v_mfma_f32_16x16x32_bf16 v[80:83], v[56:59], v[40:43], v[80:83]
    v_mfma_f32_16x16x32_bf16 v[80:83], v[60:63], v[44:47], v[80:83]
    s_add_u32 m0, s31, 4096
    s_nop 0
    buffer_load_dwordx4 v10, s[12:15], s29 offen offset:0 nt lds
    buffer_load_dwordx4 v11, s[12:15], s29 offen offset:1024 nt lds
    buffer_load_dwordx4 v12, s[12:15], s29 offen offset:2048 nt lds
    buffer_load_dwordx4 v13, s[12:15], s29 offen offset:3072 nt lds
    s_add_u32 s29, s29, 32768
    s_nop 1
    v_cvt_pk_bf16_f32 v29, v80, v81
    v_lshlrev_b32 v80, 16, v29
    v_and_b32 v81, 0xffff0000, v29
    v_cvt_pk_bf16_f32 v29, v82, v83
    v_lshlrev_b32 v82, 16, v29
    v_and_b32 v83, 0xffff0000, v29
    v_mul_f32 v80, 0x3db504f3, v80
    v_mul_f32 v81, 0x3db504f3, v81
    v_mul_f32 v82, 0x3db504f3, v82
    v_mul_f32 v83, 0x3db504f3, v83
    v_cvt_pk_bf16_f32 v29, v80, v81
    v_lshlrev_b32 v80, 16, v29
    v_and_b32 v81, 0xffff0000, v29
    v_cvt_pk_bf16_f32 v29, v82, v83
    v_lshlrev_b32 v82, 16, v29
    v_and_b32 v83, 0xffff0000, v29
    v_max3_f32 v28, v80, v81, v82
    v_max_f32 v28, v28, v83
    v_mov_b32 v29, v28
    s_nop 1
    v_permlane16_swap_b32 v28, v29
    s_nop 0
    v_max_f32 v28, v28, v29
    v_mov_b32 v29, v28
    s_nop 1
    v_permlane32_swap_b32 v28, v29
    s_nop 0
    v_max_f32 v28, v28, v29
    v_max_f32 v28, v28, v86
    v_sub_f32 v29, v86, v28
    v_mul_f32 v29, 0x3fb8aa3b, v29
    v_exp_f32 v30, v29
    v_mul_f32 v31, 0xbfb8aa3b, v28
    v_mov_b32 v86, v28
    v_fma_f32 v80, v80, s34, v31
    v_fma_f32 v81, v81, s34, v31
    v_fma_f32 v82, v82, s34, v31
    v_fma_f32 v83, v83, s34, v31
    v_exp_f32 v80, v80
    v_exp_f32 v81, v81
    v_exp_f32 v82, v82
    v_exp_f32 v83, v83
    v_mul_f32 v87, v87, v30
    s_waitcnt vmcnt(51)
    ds_read_b64_tr_b16 v[64:65], v20 offset:12288
    ds_read_b64_tr_b16 v[66:67], v21 offset:12288
    ds_read_b64_tr_b16 v[68:69], v22 offset:12288
    ds_read_b64_tr_b16 v[70:71], v23 offset:12288
    ds_read_b64_tr_b16 v[72:73], v24 offset:12288
    ds_read_b64_tr_b16 v[74:75], v25 offset:12288
    ds_read_b64_tr_b16 v[76:77], v26 offset:12288
    ds_read_b64_tr_b16 v[78:79], v27 offset:12288
    v_mul_f32 v96, v96, v30
    v_mul_f32 v97, v97, v30
    v_mul_f32 v98, v98, v30
    v_mul_f32 v99, v99, v30
    v_mul_f32 v100, v100, v30
    v_mul_f32 v101, v101, v30
    v_mul_f32 v102, v102, v30
    v_mul_f32 v103, v103, v30
    v_mul_f32 v104, v104, v30
    v_mul_f32 v105, v105, v30
    v_mul_f32 v106, v106, v30
    v_mul_f32 v107, v107, v30
    v_mul_f32 v108, v108, v30
    v_mul_f32 v109, v109, v30
    v_mul_f32 v110, v110, v30
    v_mul_f32 v111, v111, v30
    v_mul_f32 v112, v112, v30
    v_mul_f32 v113, v113, v30
    v_mul_f32 v114, v114, v30
    v_mul_f32 v115, v115, v30
    v_mul_f32 v116, v116, v30
    v_mul_f32 v117, v117, v30
    v_mul_f32 v118, v118, v30
    v_mul_f32 v119, v119, v30
    v_mul_f32 v120, v120, v30
    v_mul_f32 v121, v121, v30
    v_mul_f32 v122, v122, v30
    v_mul_f32 v123, v123, v30
    v_mul_f32 v124, v124, v30
    v_mul_f32 v125, v125, v30
    v_mul_f32 v126, v126, v30
    v_mul_f32 v127, v127, v30
    v_add_f32 v87, v87, v80
    v_add_f32 v87, v87, v81
    v_add_f32 v87, v87, v82
    v_add_f32 v87, v87, v83
    v_cvt_pk_bf16_f32 v84, v80, v81
    v_cvt_pk_bf16_f32 v85, v82, v83
    s_waitcnt lgkmcnt(0)
    s_nop 1
    v_mfma_f32_16x16x16_bf16 v[96:99], v[64:65], v[84:85], v[96:99]
    v_mfma_f32_16x16x16_bf16 v[100:103], v[66:67], v[84:85], v[100:103]
    v_mfma_f32_16x16x16_bf16 v[104:107], v[68:69], v[84:85], v[104:107]
    v_mfma_f32_16x16x16_bf16 v[108:111], v[70:71], v[84:85], v[108:111]
    v_mfma_f32_16x16x16_bf16 v[112:115], v[72:73], v[84:85], v[112:115]
    v_mfma_f32_16x16x16_bf16 v[116:119], v[74:75], v[84:85], v[116:119]
    v_mfma_f32_16x16x16_bf16 v[120:123], v[76:77], v[84:85], v[120:123]
    v_mfma_f32_16x16x16_bf16 v[124:127], v[78:79], v[84:85], v[124:127]
    s_add_u32 m0, s31, 12288
    s_nop 0
    buffer_load_dwordx4 v14, s[16:19], s40 offen offset:0 nt lds
    buffer_load_dwordx4 v15, s[16:19], s40 offen offset:1024 nt lds
    buffer_load_dwordx4 v14, s[16:19], s40 offen offset:2048 nt lds
    buffer_load_dwordx4 v15, s[16:19], s40 offen offset:3072 nt lds
    s_add_u32 s40, s40, 32768
    s_mov_b32 s35, 0
L_a_loop:
    s_waitcnt vmcnt(12)
    ds_read_b128 v[48:51], v16 offset:0
    ds_read_b128 v[52:55], v17 offset:0
    ds_read_b128 v[56:59], v18 offset:0
    ds_read_b128 v[60:63], v19 offset:0
    s_waitcnt lgkmcnt(0)
    v_mfma_f32_16x16x32_bf16 v[80:83], v[48:51], v[32:35], 0
    v_mfma_f32_16x16x32_bf16 v[80:83], v[52:55], v[36:39], v[80:83]
    v_mfma_f32_16x16x32_bf16 v[80:83], v[56:59], v[40:43], v[80:83]
    v_mfma_f32_16x16x32_bf16 v[80:83], v[60:63], v[44:47], v[80:83]
    s_add_u32 m0, s31, 0
    s_nop 0
    buffer_load_dwordx4 v10, s[12:15], s29 offen offset:0 nt lds
    buffer_load_dwordx4 v11, s[12:15], s29 offen offset:1024 nt lds
    buffer_load_dwordx4 v12, s[12:15], s29 offen offset:2048 nt lds
    buffer_load_dwordx4 v13, s[12:15], s29 offen offset:3072 nt lds
    s_add_u32 s29, s29, 32768
    s_nop 1
    v_cvt_pk_bf16_f32 v29, v80, v81
    v_lshlrev_b32 v80, 16, v29
    v_and_b32 v81, 0xffff0000, v29
    v_cvt_pk_bf16_f32 v29, v82, v83
    v_lshlrev_b32 v82, 16, v29
    v_and_b32 v83, 0xffff0000, v29
    v_mul_f32 v80, 0x3db504f3, v80
    v_mul_f32 v81, 0x3db504f3, v81
    v_mul_f32 v82, 0x3db504f3, v82
    v_mul_f32 v83, 0x3db504f3, v83
    v_cvt_pk_bf16_f32 v29, v80, v81
    v_lshlrev_b32 v80, 16, v29
    v_and_b32 v81, 0xffff0000, v29
    v_cvt_pk_bf16_f32 v29, v82, v83
    v_lshlrev_b32 v82, 16, v29
    v_and_b32 v83, 0xffff0000, v29
    v_max3_f32 v28, v80, v81, v82
    v_max_f32 v28, v28, v83
    v_mov_b32 v29, v28
    s_nop 1
    v_permlane16_swap_b32 v28, v29
    s_nop 0
    v_max_f32 v28, v28, v29
    v_mov_b32 v29, v28
    s_nop 1
    v_permlane32_swap_b32 v28, v29
    s_nop 0
    v_max_f32 v28, v28, v29
    v_max_f32 v28, v28, v86
    v_sub_f32 v29, v86, v28
    v_mul_f32 v29, 0x3fb8aa3b, v29
    v_exp_f32 v30, v29
    v_mul_f32 v31, 0xbfb8aa3b, v28
    v_mov_b32 v86, v28
    v_fma_f32 v80, v80, s34, v31
    v_fma_f32 v81, v81, s34, v31
    v_fma_f32 v82, v82, s34, v31
    v_fma_f32 v83, v83, s34, v31
    v_exp_f32 v80, v80
    v_exp_f32 v81, v81
    v_exp_f32 v82, v82
    v_exp_f32 v83, v83
    v_mul_f32 v87, v87, v30
    s_waitcnt vmcnt(12)
    ds_read_b64_tr_b16 v[64:65], v20 offset:8192
    ds_read_b64_tr_b16 v[66:67], v21 offset:8192
    ds_read_b64_tr_b16 v[68:69], v22 offset:8192
    ds_read_b64_tr_b16 v[70:71], v23 offset:8192
    ds_read_b64_tr_b16 v[72:73], v24 offset:8192
    ds_read_b64_tr_b16 v[74:75], v25 offset:8192
    ds_read_b64_tr_b16 v[76:77], v26 offset:8192
    ds_read_b64_tr_b16 v[78:79], v27 offset:8192
    v_mul_f32 v96, v96, v30
    v_mul_f32 v97, v97, v30
    v_mul_f32 v98, v98, v30
    v_mul_f32 v99, v99, v30
    v_mul_f32 v100, v100, v30
    v_mul_f32 v101, v101, v30
    v_mul_f32 v102, v102, v30
    v_mul_f32 v103, v103, v30
    v_mul_f32 v104, v104, v30
    v_mul_f32 v105, v105, v30
    v_mul_f32 v106, v106, v30
    v_mul_f32 v107, v107, v30
    v_mul_f32 v108, v108, v30
    v_mul_f32 v109, v109, v30
    v_mul_f32 v110, v110, v30
    v_mul_f32 v111, v111, v30
    v_mul_f32 v112, v112, v30
    v_mul_f32 v113, v113, v30
    v_mul_f32 v114, v114, v30
    v_mul_f32 v115, v115, v30
    v_mul_f32 v116, v116, v30
    v_mul_f32 v117, v117, v30
    v_mul_f32 v118, v118, v30
    v_mul_f32 v119, v119, v30
    v_mul_f32 v120, v120, v30
    v_mul_f32 v121, v121, v30
    v_mul_f32 v122, v122, v30
    v_mul_f32 v123, v123, v30
    v_mul_f32 v124, v124, v30
    v_mul_f32 v125, v125, v30
    v_mul_f32 v126, v126, v30
    v_mul_f32 v127, v127, v30
    v_add_f32 v87, v87, v80
    v_add_f32 v87, v87, v81
    v_add_f32 v87, v87, v82
    v_add_f32 v87, v87, v83
    v_cvt_pk_bf16_f32 v84, v80, v81
    v_cvt_pk_bf16_f32 v85, v82, v83
    s_waitcnt lgkmcnt(0)
    s_nop 1
    v_mfma_f32_16x16x16_bf16 v[96:99], v[64:65], v[84:85], v[96:99]
    v_mfma_f32_16x16x16_bf16 v[100:103], v[66:67], v[84:85], v[100:103]
    v_mfma_f32_16x16x16_bf16 v[104:107], v[68:69], v[84:85], v[104:107]
    v_mfma_f32_16x16x16_bf16 v[108:111], v[70:71], v[84:85], v[108:111]
    v_mfma_f32_16x16x16_bf16 v[112:115], v[72:73], v[84:85], v[112:115]
    v_mfma_f32_16x16x16_bf16 v[116:119], v[74:75], v[84:85], v[116:119]
    v_mfma_f32_16x16x16_bf16 v[120:123], v[76:77], v[84:85], v[120:123]
    v_mfma_f32_16x16x16_bf16 v[124:127], v[78:79], v[84:85], v[124:127]
    s_add_u32 m0, s31, 8192
    s_nop 0
    buffer_load_dwordx4 v14, s[16:19], s40 offen offset:0 nt lds
    buffer_load_dwordx4 v15, s[16:19], s40 offen offset:1024 nt lds
    buffer_load_dwordx4 v14, s[16:19], s40 offen offset:2048 nt lds
    buffer_load_dwordx4 v15, s[16:19], s40 offen offset:3072 nt lds
    s_add_u32 s40, s40, 32768
    s_waitcnt vmcnt(12)
    ds_read_b128 v[48:51], v16 offset:4096
    ds_read_b128 v[52:55], v17 offset:4096
    ds_read_b128 v[56:59], v18 offset:4096
    ds_read_b128 v[60:63], v19 offset:4096
    s_waitcnt lgkmcnt(0)
    v_mfma_f32_16x16x32_bf16 v[80:83], v[48:51], v[32:35], 0
    v_mfma_f32_16x16x32_bf16 v[80:83], v[52:55], v[36:39], v[80:83]
    v_mfma_f32_16x16x32_bf16 v[80:83], v[56:59], v[40:43], v[80:83]
    v_mfma_f32_16x16x32_bf16 v[80:83], v[60:63], v[44:47], v[80:83]
    s_add_u32 m0, s31, 4096
    s_nop 0
    buffer_load_dwordx4 v10, s[12:15], s29 offen offset:0 nt lds
    buffer_load_dwordx4 v11, s[12:15], s29 offen offset:1024 nt lds
    buffer_load_dwordx4 v12, s[12:15], s29 offen offset:2048 nt lds
    buffer_load_dwordx4 v13, s[12:15], s29 offen offset:3072 nt lds
    s_add_u32 s29, s29, 32768
    s_nop 1
    v_cvt_pk_bf16_f32 v29, v80, v81
    v_lshlrev_b32 v80, 16, v29
    v_and_b32 v81, 0xffff0000, v29
    v_cvt_pk_bf16_f32 v29, v82, v83
    v_lshlrev_b32 v82, 16, v29
    v_and_b32 v83, 0xffff0000, v29
    v_mul_f32 v80, 0x3db504f3, v80
    v_mul_f32 v81, 0x3db504f3, v81
    v_mul_f32 v82, 0x3db504f3, v82
    v_mul_f32 v83, 0x3db504f3, v83
    v_cvt_pk_bf16_f32 v29, v80, v81
    v_lshlrev_b32 v80, 16, v29
    v_and_b32 v81, 0xffff0000, v29
    v_cvt_pk_bf16_f32 v29, v82, v83
    v_lshlrev_b32 v82, 16, v29
    v_and_b32 v83, 0xffff0000, v29
    v_max3_f32 v28, v80, v81, v82
    v_max_f32 v28, v28, v83
    v_mov_b32 v29, v28
    s_nop 1
    v_permlane16_swap_b32 v28, v29
    s_nop 0
    v_max_f32 v28, v28, v29
    v_mov_b32 v29, v28
    s_nop 1
    v_permlane32_swap_b32 v28, v29
    s_nop 0
    v_max_f32 v28, v28, v29
    v_max_f32 v28, v28, v86
    v_sub_f32 v29, v86, v28
    v_mul_f32 v29, 0x3fb8aa3b, v29
    v_exp_f32 v30, v29
    v_mul_f32 v31, 0xbfb8aa3b, v28
    v_mov_b32 v86, v28
    v_fma_f32 v80, v80, s34, v31
    v_fma_f32 v81, v81, s34, v31
    v_fma_f32 v82, v82, s34, v31
    v_fma_f32 v83, v83, s34, v31
    v_exp_f32 v80, v80
    v_exp_f32 v81, v81
    v_exp_f32 v82, v82
    v_exp_f32 v83, v83
    v_mul_f32 v87, v87, v30
    s_waitcnt vmcnt(12)
    ds_read_b64_tr_b16 v[64:65], v20 offset:12288
    ds_read_b64_tr_b16 v[66:67], v21 offset:12288
    ds_read_b64_tr_b16 v[68:69], v22 offset:12288
    ds_read_b64_tr_b16 v[70:71], v23 offset:12288
    ds_read_b64_tr_b16 v[72:73], v24 offset:12288
    ds_read_b64_tr_b16 v[74:75], v25 offset:12288
    ds_read_b64_tr_b16 v[76:77], v26 offset:12288
    ds_read_b64_tr_b16 v[78:79], v27 offset:12288
    v_mul_f32 v96, v96, v30
    v_mul_f32 v97, v97, v30
    v_mul_f32 v98, v98, v30
    v_mul_f32 v99, v99, v30
    v_mul_f32 v100, v100, v30
    v_mul_f32 v101, v101, v30
    v_mul_f32 v102, v102, v30
    v_mul_f32 v103, v103, v30
    v_mul_f32 v104, v104, v30
    v_mul_f32 v105, v105, v30
    v_mul_f32 v106, v106, v30
    v_mul_f32 v107, v107, v30
    v_mul_f32 v108, v108, v30
    v_mul_f32 v109, v109, v30
    v_mul_f32 v110, v110, v30
    v_mul_f32 v111, v111, v30
    v_mul_f32 v112, v112, v30
    v_mul_f32 v113, v113, v30
    v_mul_f32 v114, v114, v30
    v_mul_f32 v115, v115, v30
    v_mul_f32 v116, v116, v30
    v_mul_f32 v117, v117, v30
    v_mul_f32 v118, v118, v30
    v_mul_f32 v119, v119, v30
    v_mul_f32 v120, v120, v30
    v_mul_f32 v121, v121, v30
    v_mul_f32 v122, v122, v30
    v_mul_f32 v123, v123, v30
    v_mul_f32 v124, v124, v30
    v_mul_f32 v125, v125, v30
    v_mul_f32 v126, v126, v30
    v_mul_f32 v127, v127, v30
    v_add_f32 v87, v87, v80
    v_add_f32 v87, v87, v81
    v_add_f32 v87, v87, v82
    v_add_f32 v87, v87, v83
    v_cvt_pk_bf16_f32 v84, v80, v81
    v_cvt_pk_bf16_f32 v85, v82, v83
    s_waitcnt lgkmcnt(0)
    s_nop 1
    v_mfma_f32_16x16x16_bf16 v[96:99], v[64:65], v[84:85], v[96:99]
    v_mfma_f32_16x16x16_bf16 v[100:103], v[66:67], v[84:85], v[100:103]
    v_mfma_f32_16x16x16_bf16 v[104:107], v[68:69], v[84:85], v[104:107]
    v_mfma_f32_16x16x16_bf16 v[108:111], v[70:71], v[84:85], v[108:111]
    v_mfma_f32_16x16x16_bf16 v[112:115], v[72:73], v[84:85], v[112:115]
    v_mfma_f32_16x16x16_bf16 v[116:119], v[74:75], v[84:85], v[116:119]
    v_mfma_f32_16x16x16_bf16 v[120:123], v[76:77], v[84:85], v[120:123]
    v_mfma_f32_16x16x16_bf16 v[124:127], v[78:79], v[84:85], v[124:127]
    s_add_u32 m0, s31, 12288
    s_nop 0
    buffer_load_dwordx4 v14, s[16:19], s40 offen offset:0 nt lds
    buffer_load_dwordx4 v15, s[16:19], s40 offen offset:1024 nt lds
    buffer_load_dwordx4 v14, s[16:19], s40 offen offset:2048 nt lds
    buffer_load_dwordx4 v15, s[16:19], s40 offen offset:3072 nt lds
    s_add_u32 s40, s40, 32768
    s_add_u32 s35, s35, 1
    s_cmp_lt_u32 s35, 6
    s_cbranch_scc1 L_a_loop
    s_waitcnt vmcnt(12)
    ds_read_b128 v[48:51], v16 offset:0
    ds_read_b128 v[52:55], v17 offset:0
    ds_read_b128 v[56:59], v18 offset:0
    ds_read_b128 v[60:63], v19 offset:0
    s_waitcnt lgkmcnt(0)
    v_mfma_f32_16x16x32_bf16 v[80:83], v[48:51], v[32:35], 0
    v_mfma_f32_16x16x32_bf16 v[80:83], v[52:55], v[36:39], v[80:83]
    v_mfma_f32_16x16x32_bf16 v[80:83], v[56:59], v[40:43], v[80:83]
    v_mfma_f32_16x16x32_bf16 v[80:83], v[60:63], v[44:47], v[80:83]
    s_nop 7
    v_cvt_pk_bf16_f32 v29, v80, v81
    v_lshlrev_b32 v80, 16, v29
    v_and_b32 v81, 0xffff0000, v29
    v_cvt_pk_bf16_f32 v29, v82, v83
    v_lshlrev_b32 v82, 16, v29
    v_and_b32 v83, 0xffff0000, v29
    v_mul_f32 v80, 0x3db504f3, v80
    v_mul_f32 v81, 0x3db504f3, v81
    v_mul_f32 v82, 0x3db504f3, v82
    v_mul_f32 v83, 0x3db504f3, v83
    v_cvt_pk_bf16_f32 v29, v80, v81
    v_lshlrev_b32 v80, 16, v29
    v_and_b32 v81, 0xffff0000, v29
    v_cvt_pk_bf16_f32 v29, v82, v83
    v_lshlrev_b32 v82, 16, v29
    v_and_b32 v83, 0xffff0000, v29
    v_max3_f32 v28, v80, v81, v82
    v_max_f32 v28, v28, v83
    v_mov_b32 v29, v28
    s_nop 1
    v_permlane16_swap_b32 v28, v29
    s_nop 0
    v_max_f32 v28, v28, v29
    v_mov_b32 v29, v28
    s_nop 1
    v_permlane32_swap_b32 v28, v29
    s_nop 0
    v_max_f32 v28, v28, v29
    v_max_f32 v28, v28, v86
    v_sub_f32 v29, v86, v28
    v_mul_f32 v29, 0x3fb8aa3b, v29
    v_exp_f32 v30, v29
    v_mul_f32 v31, 0xbfb8aa3b, v28
    v_mov_b32 v86, v28
    v_fma_f32 v80, v80, s34, v31
    v_fma_f32 v81, v81, s34, v31
    v_fma_f32 v82, v82, s34, v31
    v_fma_f32 v83, v83, s34, v31
    v_exp_f32 v80, v80
    v_exp_f32 v81, v81
    v_exp_f32 v82, v82
    v_exp_f32 v83, v83
    v_mul_f32 v87, v87, v30
    s_waitcnt vmcnt(8)
    ds_read_b64_tr_b16 v[64:65], v20 offset:8192
    ds_read_b64_tr_b16 v[66:67], v21 offset:8192
    ds_read_b64_tr_b16 v[68:69], v22 offset:8192
    ds_read_b64_tr_b16 v[70:71], v23 offset:8192
    ds_read_b64_tr_b16 v[72:73], v24 offset:8192
    ds_read_b64_tr_b16 v[74:75], v25 offset:8192
    ds_read_b64_tr_b16 v[76:77], v26 offset:8192
    ds_read_b64_tr_b16 v[78:79], v27 offset:8192
    v_mul_f32 v96, v96, v30
    v_mul_f32 v97, v97, v30
    v_mul_f32 v98, v98, v30
    v_mul_f32 v99, v99, v30
    v_mul_f32 v100, v100, v30
    v_mul_f32 v101, v101, v30
    v_mul_f32 v102, v102, v30
    v_mul_f32 v103, v103, v30
    v_mul_f32 v104, v104, v30
    v_mul_f32 v105, v105, v30
    v_mul_f32 v106, v106, v30
    v_mul_f32 v107, v107, v30
    v_mul_f32 v108, v108, v30
    v_mul_f32 v109, v109, v30
    v_mul_f32 v110, v110, v30
    v_mul_f32 v111, v111, v30
    v_mul_f32 v112, v112, v30
    v_mul_f32 v113, v113, v30
    v_mul_f32 v114, v114, v30
    v_mul_f32 v115, v115, v30
    v_mul_f32 v116, v116, v30
    v_mul_f32 v117, v117, v30
    v_mul_f32 v118, v118, v30
    v_mul_f32 v119, v119, v30
    v_mul_f32 v120, v120, v30
    v_mul_f32 v121, v121, v30
    v_mul_f32 v122, v122, v30
    v_mul_f32 v123, v123, v30
    v_mul_f32 v124, v124, v30
    v_mul_f32 v125, v125, v30
    v_mul_f32 v126, v126, v30
    v_mul_f32 v127, v127, v30
    v_add_f32 v87, v87, v80
    v_add_f32 v87, v87, v81
    v_add_f32 v87, v87, v82
    v_add_f32 v87, v87, v83
    v_cvt_pk_bf16_f32 v84, v80, v81
    v_cvt_pk_bf16_f32 v85, v82, v83
    s_waitcnt lgkmcnt(0)
    s_nop 1
    v_mfma_f32_16x16x16_bf16 v[96:99], v[64:65], v[84:85], v[96:99]
    v_mfma_f32_16x16x16_bf16 v[100:103], v[66:67], v[84:85], v[100:103]
    v_mfma_f32_16x16x16_bf16 v[104:107], v[68:69], v[84:85], v[104:107]
    v_mfma_f32_16x16x16_bf16 v[108:111], v[70:71], v[84:85], v[108:111]
    v_mfma_f32_16x16x16_bf16 v[112:115], v[72:73], v[84:85], v[112:115]
    v_mfma_f32_16x16x16_bf16 v[116:119], v[74:75], v[84:85], v[116:119]
    v_mfma_f32_16x16x16_bf16 v[120:123], v[76:77], v[84:85], v[120:123]
    v_mfma_f32_16x16x16_bf16 v[124:127], v[78:79], v[84:85], v[124:127]
    s_nop 3
    s_waitcnt vmcnt(4)
    ds_read_b128 v[48:51], v16 offset:4096
    ds_read_b128 v[52:55], v17 offset:4096
    ds_read_b128 v[56:59], v18 offset:4096
    ds_read_b128 v[60:63], v19 offset:4096
    s_waitcnt lgkmcnt(0)
    v_mfma_f32_16x16x32_bf16 v[80:83], v[48:51], v[32:35], 0
    v_mfma_f32_16x16x32_bf16 v[80:83], v[52:55], v[36:39], v[80:83]
    v_mfma_f32_16x16x32_bf16 v[80:83], v[56:59], v[40:43], v[80:83]
    v_mfma_f32_16x16x32_bf16 v[80:83], v[60:63], v[44:47], v[80:83]
    s_nop 7
    v_cvt_pk_bf16_f32 v29, v80, v81
    v_lshlrev_b32 v80, 16, v29
    v_and_b32 v81, 0xffff0000, v29
    v_cvt_pk_bf16_f32 v29, v82, v83
    v_lshlrev_b32 v82, 16, v29
    v_and_b32 v83, 0xffff0000, v29
    v_mul_f32 v80, 0x3db504f3, v80
    v_mul_f32 v81, 0x3db504f3, v81
    v_mul_f32 v82, 0x3db504f3, v82
    v_mul_f32 v83, 0x3db504f3, v83
    v_cvt_pk_bf16_f32 v29, v80, v81
    v_lshlrev_b32 v80, 16, v29
    v_and_b32 v81, 0xffff0000, v29
    v_cvt_pk_bf16_f32 v29, v82, v83
    v_lshlrev_b32 v82, 16, v29
    v_and_b32 v83, 0xffff0000, v29
    v_max3_f32 v28, v80, v81, v82
    v_max_f32 v28, v28, v83
    v_mov_b32 v29, v28
    s_nop 1
    v_permlane16_swap_b32 v28, v29
    s_nop 0
    v_max_f32 v28, v28, v29
    v_mov_b32 v29, v28
    s_nop 1
    v_permlane32_swap_b32 v28, v29
    s_nop 0
    v_max_f32 v28, v28, v29
    v_max_f32 v28, v28, v86
    v_sub_f32 v29, v86, v28
    v_mul_f32 v29, 0x3fb8aa3b, v29
    v_exp_f32 v30, v29
    v_mul_f32 v31, 0xbfb8aa3b, v28
    v_mov_b32 v86, v28
    v_fma_f32 v80, v80, s34, v31
    v_fma_f32 v81, v81, s34, v31
    v_fma_f32 v82, v82, s34, v31
    v_fma_f32 v83, v83, s34, v31
    v_exp_f32 v80, v80
    v_exp_f32 v81, v81
    v_exp_f32 v82, v82
    v_exp_f32 v83, v83
    v_mul_f32 v87, v87, v30
    s_waitcnt vmcnt(0)
    ds_read_b64_tr_b16 v[64:65], v20 offset:12288
    ds_read_b64_tr_b16 v[66:67], v21 offset:12288
    ds_read_b64_tr_b16 v[68:69], v22 offset:12288
    ds_read_b64_tr_b16 v[70:71], v23 offset:12288
    ds_read_b64_tr_b16 v[72:73], v24 offset:12288
    ds_read_b64_tr_b16 v[74:75], v25 offset:12288
    ds_read_b64_tr_b16 v[76:77], v26 offset:12288
    ds_read_b64_tr_b16 v[78:79], v27 offset:12288
    v_mul_f32 v96, v96, v30
    v_mul_f32 v97, v97, v30
    v_mul_f32 v98, v98, v30
    v_mul_f32 v99, v99, v30
    v_mul_f32 v100, v100, v30
    v_mul_f32 v101, v101, v30
    v_mul_f32 v102, v102, v30
    v_mul_f32 v103, v103, v30
    v_mul_f32 v104, v104, v30
    v_mul_f32 v105, v105, v30
    v_mul_f32 v106, v106, v30
    v_mul_f32 v107, v107, v30
    v_mul_f32 v108, v108, v30
    v_mul_f32 v109, v109, v30
    v_mul_f32 v110, v110, v30
    v_mul_f32 v111, v111, v30
    v_mul_f32 v112, v112, v30
    v_mul_f32 v113, v113, v30
    v_mul_f32 v114, v114, v30
    v_mul_f32 v115, v115, v30
    v_mul_f32 v116, v116, v30
    v_mul_f32 v117, v117, v30
    v_mul_f32 v118, v118, v30
    v_mul_f32 v119, v119, v30
    v_mul_f32 v120, v120, v30
    v_mul_f32 v121, v121, v30
    v_mul_f32 v122, v122, v30
    v_mul_f32 v123, v123, v30
    v_mul_f32 v124, v124, v30
    v_mul_f32 v125, v125, v30
    v_mul_f32 v126, v126, v30
    v_mul_f32 v127, v127, v30
    v_add_f32 v87, v87, v80
    v_add_f32 v87, v87, v81
    v_add_f32 v87, v87, v82
    v_add_f32 v87, v87, v83
    v_cvt_pk_bf16_f32 v84, v80, v81
    v_cvt_pk_bf16_f32 v85, v82, v83
    s_waitcnt lgkmcnt(0)
    s_nop 1
    v_mfma_f32_16x16x16_bf16 v[96:99], v[64:65], v[84:85], v[96:99]
    v_mfma_f32_16x16x16_bf16 v[100:103], v[66:67], v[84:85], v[100:103]
    v_mfma_f32_16x16x16_bf16 v[104:107], v[68:69], v[84:85], v[104:107]
    v_mfma_f32_16x16x16_bf16 v[108:111], v[70:71], v[84:85], v[108:111]
    v_mfma_f32_16x16x16_bf16 v[112:115], v[72:73], v[84:85], v[112:115]
    v_mfma_f32_16x16x16_bf16 v[116:119], v[74:75], v[84:85], v[116:119]
    v_mfma_f32_16x16x16_bf16 v[120:123], v[76:77], v[84:85], v[120:123]
    v_mfma_f32_16x16x16_bf16 v[124:127], v[78:79], v[84:85], v[124:127]
    s_nop 3
    s_nop 7
    s_nop 1
    v_mov_b32 v29, v87
    s_nop 1
    v_permlane16_swap_b32 v87, v29
    s_nop 0
    v_add_f32 v87, v87, v29
    v_mov_b32 v29, v87
    s_nop 1
    v_permlane32_swap_b32 v87, v29
    s_nop 0
    v_add_f32 v87, v87, v29
    v_lshlrev_b32 v5, 9, v4
    v_lshl_add_u32 v5, v3, 4, v5
    v_add_u32 v5, s31, v5
    v_lshlrev_b32 v6, 3, v4
    v_add_u32 v6, s31, v6
    v_cmp_gt_u32 vcc, 4, v4
    s_and_saveexec_b64 s[36:37], vcc
    ds_write_b128 v5, v[96:99] offset:0
    ds_write_b128 v5, v[100:103] offset:64
    ds_write_b128 v5, v[104:107] offset:128
    ds_write_b128 v5, v[108:111] offset:192
    ds_write_b128 v5, v[112:115] offset:256
    ds_write_b128 v5, v[116:119] offset:320
    ds_write_b128 v5, v[120:123] offset:384
    ds_write_b128 v5, v[124:127] offset:448
    ds_write_b64 v6, v[86:87] offset:2048
    s_mov_b64 exec, s[36:37]
    s_lshl_b32 s32, s28, 9
    v_lshl_add_u32 v5, v2, 3, s32
    v_add_u32 v6, 0x10000, v5
    s_lshl_b32 s32, s28, 3
    v_mov_b32 v7, s32
    v_add_u32 v8, 0x10000, v7
    v_lshlrev_b32 v9, 4, v2
    v_mov_b32 v30, 0
    v_mov_b32 v25, s43
    v_mov_b32 v27, s43
    s_waitcnt lgkmcnt(0)
    s_barrier
    s_cmp_ge_u32 s24, 4
    s_cbranch_scc1 L_nopub
    ds_read_b64 v[64:65], v7 offset:2048
    ds_read_b64 v[66:67], v7 offset:18432
    ds_read_b64 v[68:69], v7 offset:34816
    ds_read_b64 v[70:71], v7 offset:51200
    ds_read_b64 v[72:73], v8 offset:2048
    ds_read_b64 v[74:75], v8 offset:18432
    ds_read_b64 v[76:77], v8 offset:34816
    ds_read_b64 v[78:79], v8 offset:51200
    ds_read_b64 v[48:49], v5 offset:0
    ds_read_b64 v[50:51], v5 offset:16384
    ds_read_b64 v[52:53], v5 offset:32768
    ds_read_b64 v[54:55], v5 offset:49152
    ds_read_b64 v[56:57], v6 offset:0
    ds_read_b64 v[58:59], v6 offset:16384
    ds_read_b64 v[60:61], v6 offset:32768
    ds_read_b64 v[62:63], v6 offset:49152
    s_lshl_b32 s32, s2, 12
    s_lshl_b32 s33, s28, 10
    s_add_u32 s32, s32, s33
    s_add_u32 s32, s32, 1048576
    s_lshl_b32 s33, s2, 6
    s_lshl_b32 s35, s28, 4
    s_add_u32 s33, s33, s35
    s_add_u32 s33, s33, 2097152
    s_waitcnt lgkmcnt(0)
    v_max3_f32 v20, v64, v66, v68
    v_max3_f32 v20, v20, v70, v72
    v_max3_f32 v20, v20, v74, v76
    v_max_f32 v20, v20, v78
    v_sub_f32 v19, v64, v20
    v_mul_f32 v19, 0x3fb8aa3b, v19
    v_exp_f32 v80, v19
    v_sub_f32 v19, v66, v20
    v_mul_f32 v19, 0x3fb8aa3b, v19
    v_exp_f32 v81, v19
    v_sub_f32 v19, v68, v20
    v_mul_f32 v19, 0x3fb8aa3b, v19
    v_exp_f32 v82, v19
    v_sub_f32 v19, v70, v20
    v_mul_f32 v19, 0x3fb8aa3b, v19
    v_exp_f32 v83, v19
    v_sub_f32 v19, v72, v20
    v_mul_f32 v19, 0x3fb8aa3b, v19
    v_exp_f32 v84, v19
    v_sub_f32 v19, v74, v20
    v_mul_f32 v19, 0x3fb8aa3b, v19
    v_exp_f32 v85, v19
    v_sub_f32 v19, v76, v20
    v_mul_f32 v19, 0x3fb8aa3b, v19
    v_exp_f32 v86, v19
    v_sub_f32 v19, v78, v20
    v_mul_f32 v19, 0x3fb8aa3b, v19
    v_exp_f32 v87, v19
    v_mov_b32 v21, s43
    v_mov_b32 v23, s43
    v_mul_f32 v24, v48, v80
    v_mul_f32 v26, v49, v80
    v_mul_f32 v22, v65, v80
    v_fmac_f32 v24, v50, v81
    v_fmac_f32 v26, v51, v81
    v_fmac_f32 v22, v67, v81
    v_fmac_f32 v24, v52, v82
    v_fmac_f32 v26, v53, v82
    v_fmac_f32 v22, v69, v82
    v_fmac_f32 v24, v54, v83
    v_fmac_f32 v26, v55, v83
    v_fmac_f32 v22, v71, v83
    v_fmac_f32 v24, v56, v84
    v_fmac_f32 v26, v57, v84
    v_fmac_f32 v22, v73, v84
    v_fmac_f32 v24, v58, v85
    v_fmac_f32 v26, v59, v85
    v_fmac_f32 v22, v75, v85
    v_fmac_f32 v24, v60, v86
    v_fmac_f32 v26, v61, v86
    v_fmac_f32 v22, v77, v86
    v_fmac_f32 v24, v62, v87
    v_fmac_f32 v26, v63, v87
    v_fmac_f32 v22, v79, v87
    buffer_store_dwordx4 v[24:27], v9, s[20:23], s32 offen sc1
    s_mov_b64 exec, 1
    buffer_store_dwordx4 v[20:23], v30, s[20:23], s33 offen sc1
    s_mov_b64 exec, -1
L_nopub:
    s_lshl_b32 s32, s26, 5
    s_add_u32 s32, s32, s25
    s_lshl_b32 s33, s32, 6
    s_lshl_b32 s35, s28, 4
    s_add_u32 s33, s33, s35
    s_add_u32 s33, s33, 2097152
    s_lshl_b32 s32, s32, 12
    s_lshl_b32 s35, s28, 10
    s_add_u32 s32, s32, s35
    s_add_u32 s32, s32, 1048576
    v_perm_b32 v96, v132, v128, s38
    v_perm_b32 v97, v140, v136, s38
    v_perm_b32 v98, v148, v144, s38
    v_perm_b32 v99, v156, v152, s38
    v_perm_b32 v100, v132, v128, s39
    v_perm_b32 v101, v140, v136, s39
    v_perm_b32 v102, v148, v144, s39
    v_perm_b32 v103, v156, v152, s39
    v_perm_b32 v104, v133, v129, s38
    v_perm_b32 v105, v141, v137, s38
    v_perm_b32 v106, v149, v145, s38
    v_perm_b32 v107, v157, v153, s38
    v_perm_b32 v108, v133, v129, s39
    v_perm_b32 v109, v141, v137, s39
    v_perm_b32 v110, v149, v145, s39
    v_perm_b32 v111, v157, v153, s39
    v_perm_b32 v112, v134, v130, s38
    v_perm_b32 v113, v142, v138, s38
    v_perm_b32 v114, v150, v146, s38
    v_perm_b32 v115, v158, v154, s38
    v_perm_b32 v116, v134, v130, s39
    v_perm_b32 v117, v142, v138, s39
    v_perm_b32 v118, v150, v146, s39
    v_perm_b32 v119, v158, v154, s39
    v_perm_b32 v120, v135, v131, s38
    v_perm_b32 v121, v143, v139, s38
    v_perm_b32 v122, v151, v147, s38
    v_perm_b32 v123, v159, v155, s38
    v_perm_b32 v124, v135, v131, s39
    v_perm_b32 v125, v143, v139, s39
    v_perm_b32 v126, v151, v147, s39
    v_perm_b32 v127, v159, v155, s39
    v_perm_b32 v192, v164, v160, s38
    v_perm_b32 v193, v172, v168, s38
    v_perm_b32 v194, v180, v176, s38
    v_perm_b32 v195, v188, v184, s38
    v_perm_b32 v196, v164, v160, s39
    v_perm_b32 v197, v172, v168, s39
    v_perm_b32 v198, v180, v176, s39
    v_perm_b32 v199, v188, v184, s39
    v_perm_b32 v200, v165, v161, s38
    v_perm_b32 v201, v173, v169, s38
    v_perm_b32 v202, v181, v177, s38
    v_perm_b32 v203, v189, v185, s38
    v_perm_b32 v204, v165, v161, s39
    v_perm_b32 v205, v173, v169, s39
    v_perm_b32 v206, v181, v177, s39
    v_perm_b32 v207, v189, v185, s39
    v_perm_b32 v208, v166, v162, s38
    v_perm_b32 v209, v174, v170, s38
    v_perm_b32 v210, v182, v178, s38
    v_perm_b32 v211, v190, v186, s38
    v_perm_b32 v212, v166, v162, s39
    v_perm_b32 v213, v174, v170, s39
    v_perm_b32 v214, v182, v178, s39
    v_perm_b32 v215, v190, v186, s39
    v_perm_b32 v216, v167, v163, s38
    v_perm_b32 v217, v175, v171, s38
    v_perm_b32 v218, v183, v179, s38
    v_perm_b32 v219, v191, v187, s38
    v_perm_b32 v220, v167, v163, s39
    v_perm_b32 v221, v175, v171, s39
    v_perm_b32 v222, v183, v179, s39
    v_perm_b32 v223, v191, v187, s39
    s_mov_b32 s36, 0
L_poll2:
    s_add_u32 s35, s32, 0
    buffer_load_dwordx4 v[48:51], v9, s[20:23], s35 offen sc1
    s_add_u32 s35, s32, 32768
    buffer_load_dwordx4 v[52:55], v9, s[20:23], s35 offen sc1
    s_add_u32 s35, s32, 65536
    buffer_load_dwordx4 v[56:59], v9, s[20:23], s35 offen sc1
    s_add_u32 s35, s32, 98304
    buffer_load_dwordx4 v[60:63], v9, s[20:23], s35 offen sc1
    buffer_load_dwordx4 v[64:67], v30, s[20:23], s33 offen offset:0 sc1
    buffer_load_dwordx4 v[68:71], v30, s[20:23], s33 offen offset:512 sc1
    buffer_load_dwordx4 v[72:75], v30, s[20:23], s33 offen offset:1024 sc1
    buffer_load_dwordx4 v[76:79], v30, s[20:23], s33 offen offset:1536 sc1
    s_waitcnt vmcnt(0)
    v_xor_b32 v6, s43, v49
    v_xor_b32 v7, s43, v51
    v_or_b32 v6, v6, v7
    v_xor_b32 v7, s43, v53
    v_or_b32 v6, v6, v7
    v_xor_b32 v7, s43, v55
    v_or_b32 v6, v6, v7
    v_xor_b32 v7, s43, v57
    v_or_b32 v6, v6, v7
    v_xor_b32 v7, s43, v59
    v_or_b32 v6, v6, v7
    v_xor_b32 v7, s43, v61
    v_or_b32 v6, v6, v7
    v_xor_b32 v7, s43, v63
    v_or_b32 v6, v6, v7
    v_xor_b32 v7, s43, v65
    v_or_b32 v6, v6, v7
    v_xor_b32 v7, s43, v67
    v_or_b32 v6, v6, v7
    v_xor_b32 v7, s43, v69
    v_or_b32 v6, v6, v7
    v_xor_b32 v7, s43, v71
    v_or_b32 v6, v6, v7
    v_xor_b32 v7, s43, v73
    v_or_b32 v6, v6, v7
    v_xor_b32 v7, s43, v75
    v_or_b32 v6, v6, v7
    v_xor_b32 v7, s43, v77
    v_or_b32 v6, v6, v7
    v_xor_b32 v7, s43, v79
    v_or_b32 v6, v6, v7
    v_cmp_ne_u32 vcc, 0, v6
    s_cmp_eq_u64 vcc, 0
    s_cbranch_scc1 L_poll2_ok
    s_sleep 1
    s_add_u32 s36, s36, 1
    s_cmp_lt_u32 s36, 1000000
    s_cbranch_scc1 L_poll2
L_poll2_ok:
    v_max_f32 v18, v64, v68
    v_max3_f32 v18, v18, v72, v76
    v_sub_f32 v19, v64, v18
    v_mul_f32 v19, 0x3fb8aa3b, v19
    v_exp_f32 v20, v19
    v_sub_f32 v19, v68, v18
    v_mul_f32 v19, 0x3fb8aa3b, v19
    v_exp_f32 v21, v19
    v_sub_f32 v19, v72, v18
    v_mul_f32 v19, 0x3fb8aa3b, v19
    v_exp_f32 v22, v19
    v_sub_f32 v19, v76, v18
    v_mul_f32 v19, 0x3fb8aa3b, v19
    v_exp_f32 v23, v19
    s_nop 0
    v_mul_f32 v19, v66, v20
    v_mul_f32 v24, v48, v20
    v_mul_f32 v26, v50, v20
    v_fmac_f32 v19, v70, v21
    v_fmac_f32 v24, v52, v21
    v_fmac_f32 v26, v54, v21
    v_fmac_f32 v19, v74, v22
    v_fmac_f32 v24, v56, v22
    v_fmac_f32 v26, v58, v22
    v_fmac_f32 v19, v78, v23
    v_fmac_f32 v24, v60, v23
    v_fmac_f32 v26, v62, v23
    v_rcp_f32 v19, v19
    s_lshl_b32 s32, s24, 8
    s_add_u32 s32, s32, 156672
    v_mul_f32 v24, v24, v19
    v_mul_f32 v26, v26, v19
    v_cvt_pk_bf16_f32 v24, v24, v26
    v_lshl_add_u32 v6, v2, 2, s32
    ds_write_b32 v6, v24
    s_lshr_b32 s33, s24, 2
    s_lshl_b32 s33, s33, 7
    s_add_u32 s32, s32, s33
    v_lshl_add_u32 v6, v3, 4, s32
    s_waitcnt lgkmcnt(0)
    ds_read_b128 v[8:11], v6 offset:0
    ds_read_b128 v[12:15], v6 offset:64
    s_waitcnt lgkmcnt(0)
    v_mfma_f32_16x16x32_bf16 v[128:131], v[96:99], v[8:11], 0
    v_mfma_f32_16x16x32_bf16 v[132:135], v[100:103], v[8:11], 0
    v_mfma_f32_16x16x32_bf16 v[136:139], v[104:107], v[8:11], 0
    v_mfma_f32_16x16x32_bf16 v[140:143], v[108:111], v[8:11], 0
    v_mfma_f32_16x16x32_bf16 v[144:147], v[112:115], v[8:11], 0
    v_mfma_f32_16x16x32_bf16 v[148:151], v[116:119], v[8:11], 0
    v_mfma_f32_16x16x32_bf16 v[152:155], v[120:123], v[8:11], 0
    v_mfma_f32_16x16x32_bf16 v[156:159], v[124:127], v[8:11], 0
    v_mfma_f32_16x16x32_bf16 v[128:131], v[192:195], v[12:15], v[128:131]
    v_mfma_f32_16x16x32_bf16 v[132:135], v[196:199], v[12:15], v[132:135]
    v_mfma_f32_16x16x32_bf16 v[136:139], v[200:203], v[12:15], v[136:139]
    v_mfma_f32_16x16x32_bf16 v[140:143], v[204:207], v[12:15], v[140:143]
    v_mfma_f32_16x16x32_bf16 v[144:147], v[208:211], v[12:15], v[144:147]
    v_mfma_f32_16x16x32_bf16 v[148:151], v[212:215], v[12:15], v[148:151]
    v_mfma_f32_16x16x32_bf16 v[152:155], v[216:219], v[12:15], v[152:155]
    v_mfma_f32_16x16x32_bf16 v[156:159], v[220:223], v[12:15], v[156:159]
    s_lshl_b32 s32, s24, 9
    s_add_u32 s32, s32, 158720
    v_lshl_add_u32 v5, v3, 7, s32
    v_cmp_eq_u32 vcc, 0, v4
    s_nop 4
    v_mov_b32 v160, v128
    v_mov_b32 v161, v132
    v_mov_b32 v162, v136
    v_mov_b32 v163, v140
    v_mov_b32 v164, v144
    v_mov_b32 v165, v148
    v_mov_b32 v166, v152
    v_mov_b32 v167, v156
    v_mov_b32 v168, v129
    v_mov_b32 v169, v133
    v_mov_b32 v170, v137
    v_mov_b32 v171, v141
    v_mov_b32 v172, v145
    v_mov_b32 v173, v149
    v_mov_b32 v174, v153
    v_mov_b32 v175, v157
    v_mov_b32 v176, v130
    v_mov_b32 v177, v134
    v_mov_b32 v178, v138
    v_mov_b32 v179, v142
    v_mov_b32 v180, v146
    v_mov_b32 v181, v150
    v_mov_b32 v182, v154
    v_mov_b32 v183, v158
    v_mov_b32 v184, v131
    v_mov_b32 v185, v135
    v_mov_b32 v186, v139
    v_mov_b32 v187, v143
    v_mov_b32 v188, v147
    v_mov_b32 v189, v151
    v_mov_b32 v190, v155
    v_mov_b32 v191, v159
    s_and_saveexec_b64 s[36:37], vcc
    ds_write_b128 v5, v[160:163] offset:0
    ds_write_b128 v5, v[164:167] offset:16
    ds_write_b128 v5, v[168:171] offset:32
    ds_write_b128 v5, v[172:175] offset:48
    ds_write_b128 v5, v[176:179] offset:64
    ds_write_b128 v5, v[180:183] offset:80
    ds_write_b128 v5, v[184:187] offset:96
    ds_write_b128 v5, v[188:191] offset:112
    s_mov_b64 exec, s[36:37]
    s_waitcnt lgkmcnt(0)
    s_barrier
    s_cmp_lg_u32 s24, 0
    s_cbranch_scc1 L_final
    v_lshlrev_b32 v5, 3, v2
    v_add_u32 v5, 158720, v5
    ds_read_b64 v[48:49], v5 offset:0
    ds_read_b64 v[50:51], v5 offset:512
    ds_read_b64 v[52:53], v5 offset:1024
    ds_read_b64 v[54:55], v5 offset:1536
    ds_read_b64 v[56:57], v5 offset:2048
    ds_read_b64 v[58:59], v5 offset:2560
    ds_read_b64 v[60:61], v5 offset:3072
    ds_read_b64 v[62:63], v5 offset:3584
    s_lshl_b32 s32, s26, 15
    s_lshl_b32 s33, s25, 12
    s_add_u32 s32, s32, s33
    s_lshl_b32 s33, s27, 10
    s_add_u32 s32, s32, s33
    s_add_u32 s32, s32, 3145728
    v_lshlrev_b32 v5, 4, v2
    s_waitcnt lgkmcnt(0)
    v_add_f32 v24, v48, v50
    v_add_f32 v26, v49, v51
    v_add_f32 v24, v24, v52
    v_add_f32 v26, v26, v53
    v_add_f32 v24, v24, v54
    v_add_f32 v26, v26, v55
    v_add_f32 v24, v24, v56
    v_add_f32 v26, v26, v57
    v_add_f32 v24, v24, v58
    v_add_f32 v26, v26, v59
    v_add_f32 v24, v24, v60
    v_add_f32 v26, v26, v61
    v_add_f32 v24, v24, v62
    v_add_f32 v26, v26, v63
    buffer_store_dwordx4 v[24:27], v5, s[20:23], s32 offen sc1
L_final:
    v_and_b32 v5, 255, v0
    v_lshlrev_b32 v5, 4, v5
    v_lshrrev_b32 v6, 8, v0
    v_lshl_add_u32 v9, v6, 14, v5
    s_lshl_b32 s31, s26, 15
    s_add_u32 s31, s31, 3145728
    s_mov_b32 s33, 0
L_poll3:
    s_add_u32 s32, s31, 0
    buffer_load_dwordx4 v[16:19], v9, s[20:23], s32 offen sc1
    s_add_u32 s32, s31, 4096
    buffer_load_dwordx4 v[20:23], v9, s[20:23], s32 offen sc1
    s_add_u32 s32, s31, 8192
    buffer_load_dwordx4 v[24:27], v9, s[20:23], s32 offen sc1
    s_add_u32 s32, s31, 12288
    buffer_load_dwordx4 v[28:31], v9, s[20:23], s32 offen sc1
    s_waitcnt vmcnt(0)
    v_xor_b32 v10, s43, v17
    v_xor_b32 v11, s43, v19
    v_or_b32 v10, v10, v11
    v_xor_b32 v11, s43, v21
    v_or_b32 v10, v10, v11
    v_xor_b32 v11, s43, v23
    v_or_b32 v10, v10, v11
    v_xor_b32 v11, s43, v25
    v_or_b32 v10, v10, v11
    v_xor_b32 v11, s43, v27
    v_or_b32 v10, v10, v11
    v_xor_b32 v11, s43, v29
    v_or_b32 v10, v10, v11
    v_xor_b32 v11, s43, v31
    v_or_b32 v10, v10, v11
    v_cmp_ne_u32 vcc, 0, v10
    s_cmp_eq_u64 vcc, 0
    s_cbranch_scc1 L_poll3_ok
    s_sleep 1
    s_add_u32 s33, s33, 1
    s_cmp_lt_u32 s33, 1000000
    s_cbranch_scc1 L_poll3
L_poll3_ok:
    v_lshrrev_b32 v5, 1, v5
    v_lshl_add_u32 v5, v6, 11, v5
    v_add_f32 v16, v16, v20
    v_add_f32 v17, v18, v22
    v_add_f32 v24, v24, v28
    v_add_f32 v25, v26, v30
    v_add_f32 v16, v16, v24
    v_add_f32 v17, v17, v25
    ds_write_b64 v5, v[16:17] offset:0
    s_waitcnt lgkmcnt(0)
    s_barrier
    s_cmp_ge_u32 s24, 4
    s_cbranch_scc1 L_b5b
    v_lshlrev_b32 v5, 5, v2
    ds_read_b128 v[16:19], v5 offset:0
    ds_read_b128 v[20:23], v5 offset:16
    ds_read_b128 v[24:27], v5 offset:2048
    ds_read_b128 v[28:31], v5 offset:2064
    v_lshlrev_b32 v48, 16, v250
    v_and_b32 v49, 0xffff0000, v250
    v_lshlrev_b32 v50, 16, v251
    v_and_b32 v51, 0xffff0000, v251
    v_lshlrev_b32 v52, 16, v252
    v_and_b32 v53, 0xffff0000, v252
    v_lshlrev_b32 v54, 16, v253
    v_and_b32 v55, 0xffff0000, v253
    s_waitcnt lgkmcnt(0)
    v_add_f32 v16, v16, v24
    v_add_f32 v17, v17, v25
    v_add_f32 v18, v18, v26
    v_add_f32 v19, v19, v27
    v_add_f32 v20, v20, v28
    v_add_f32 v21, v21, v29
    v_add_f32 v22, v22, v30
    v_add_f32 v23, v23, v31
    v_cvt_pk_bf16_f32 v8, v16, v17
    v_lshlrev_b32 v16, 16, v8
    v_and_b32 v17, 0xffff0000, v8
    v_cvt_pk_bf16_f32 v8, v18, v19
    v_lshlrev_b32 v18, 16, v8
    v_and_b32 v19, 0xffff0000, v8
    v_cvt_pk_bf16_f32 v8, v20, v21
    v_lshlrev_b32 v20, 16, v8
    v_and_b32 v21, 0xffff0000, v8
    v_cvt_pk_bf16_f32 v8, v22, v23
    v_lshlrev_b32 v22, 16, v8
    v_and_b32 v23, 0xffff0000, v8
    v_add_f32 v16, v16, v48
    v_add_f32 v17, v17, v49
    v_add_f32 v18, v18, v50
    v_add_f32 v19, v19, v51
    v_add_f32 v20, v20, v52
    v_add_f32 v21, v21, v53
    v_add_f32 v22, v22, v54
    v_add_f32 v23, v23, v55
    v_cvt_pk_bf16_f32 v8, v16, v17
    v_lshlrev_b32 v16, 16, v8
    v_and_b32 v17, 0xffff0000, v8
    v_cvt_pk_bf16_f32 v8, v18, v19
    v_lshlrev_b32 v18, 16, v8
    v_and_b32 v19, 0xffff0000, v8
    v_cvt_pk_bf16_f32 v8, v20, v21
    v_lshlrev_b32 v20, 16, v8
    v_and_b32 v21, 0xffff0000, v8
    v_cvt_pk_bf16_f32 v8, v22, v23
    v_lshlrev_b32 v22, 16, v8
    v_and_b32 v23, 0xffff0000, v8
    ds_write_b128 v5, v[16:19] offset:8192
    ds_write_b128 v5, v[20:23] offset:8208
    v_add_f32 v8, v16, v17
    v_add_f32 v8, v8, v18
    v_add_f32 v8, v8, v19
    v_add_f32 v8, v8, v20
    v_add_f32 v8, v8, v21
    v_add_f32 v8, v8, v22
    v_add_f32 v8, v8, v23
    s_nop 1
    v_add_f32_dpp v8, v8, v8 quad_perm:[1,0,3,2] row_mask:0xf bank_mask:0xf
    s_nop 1
    v_add_f32_dpp v8, v8, v8 quad_perm:[2,3,0,1] row_mask:0xf bank_mask:0xf
    s_nop 1
    v_add_f32_dpp v8, v8, v8 row_half_mirror row_mask:0xf bank_mask:0xf
    s_nop 1
    v_add_f32_dpp v8, v8, v8 row_mirror row_mask:0xf bank_mask:0xf
    v_mov_b32 v9, v8
    s_nop 1
    v_permlane16_swap_b32 v8, v9
    s_nop 0
    v_add_f32 v8, v8, v9
    v_mov_b32 v9, v8
    s_nop 1
    v_permlane32_swap_b32 v8, v9
    s_nop 0
    v_add_f32 v8, v8, v9
    v_mul_f32 v8, 0x3b000000, v8
    v_sub_f32 v9, v16, v8
    v_mul_f32 v10, v9, v9
    v_sub_f32 v9, v17, v8
    v_fmac_f32 v10, v9, v9
    v_sub_f32 v9, v18, v8
    v_fmac_f32 v10, v9, v9
    v_sub_f32 v9, v19, v8
    v_fmac_f32 v10, v9, v9
    v_sub_f32 v9, v20, v8
    v_fmac_f32 v10, v9, v9
    v_sub_f32 v9, v21, v8
    v_fmac_f32 v10, v9, v9
    v_sub_f32 v9, v22, v8
    v_fmac_f32 v10, v9, v9
    v_sub_f32 v9, v23, v8
    v_fmac_f32 v10, v9, v9
    s_nop 1
    v_add_f32_dpp v10, v10, v10 quad_perm:[1,0,3,2] row_mask:0xf bank_mask:0xf
    s_nop 1
    v_add_f32_dpp v10, v10, v10 quad_perm:[2,3,0,1] row_mask:0xf bank_mask:0xf
    s_nop 1
    v_add_f32_dpp v10, v10, v10 row_half_mirror row_mask:0xf bank_mask:0xf
    s_nop 1
    v_add_f32_dpp v10, v10, v10 row_mirror row_mask:0xf bank_mask:0xf
    v_mov_b32 v9, v10
    s_nop 1
    v_permlane16_swap_b32 v10, v9
    s_nop 0
    v_add_f32 v10, v10, v9
    v_mov_b32 v9, v10
    s_nop 1
    v_permlane32_swap_b32 v10, v9
    s_nop 0
    v_add_f32 v10, v10, v9
    v_mul_f32 v10, 0x3b000000, v10
    v_cvt_pk_bf16_f32 v9, v8, v10
    v_lshlrev_b32 v8, 16, v9
    v_and_b32 v10, 0xffff0000, v9
    v_add_f32 v10, 0x3727c5ac, v10
    v_cvt_pk_bf16_f32 v10, v10, v10
    v_lshlrev_b32 v10, 16, v10
    v_sqrt_f32 v10, v10
    s_nop 0
    v_cvt_pk_bf16_f32 v10, v10, v10
    v_lshlrev_b32 v10, 16, v10
    v_rcp_f32 v10, v10
    v_sub_f32 v16, v16, v8
    v_sub_f32 v17, v17, v8
    v_sub_f32 v18, v18, v8
    v_sub_f32 v19, v19, v8
    v_sub_f32 v20, v20, v8
    v_sub_f32 v21, v21, v8
    v_sub_f32 v22, v22, v8
    v_sub_f32 v23, v23, v8
    v_cvt_pk_bf16_f32 v9, v16, v17
    v_lshlrev_b32 v16, 16, v9
    v_and_b32 v17, 0xffff0000, v9
    v_cvt_pk_bf16_f32 v9, v18, v19
    v_lshlrev_b32 v18, 16, v9
    v_and_b32 v19, 0xffff0000, v9
    v_cvt_pk_bf16_f32 v9, v20, v21
    v_lshlrev_b32 v20, 16, v9
    v_and_b32 v21, 0xffff0000, v9
    v_cvt_pk_bf16_f32 v9, v22, v23
    v_lshlrev_b32 v22, 16, v9
    v_and_b32 v23, 0xffff0000, v9
    v_mul_f32 v16, v16, v10
    v_mul_f32 v17, v17, v10
    v_mul_f32 v18, v18, v10
    v_mul_f32 v19, v19, v10
    v_mul_f32 v20, v20, v10
    v_mul_f32 v21, v21, v10
    v_mul_f32 v22, v22, v10
    v_mul_f32 v23, v23, v10
    v_cvt_pk_bf16_f32 v9, v16, v17
    v_lshlrev_b32 v16, 16, v9
    v_and_b32 v17, 0xffff0000, v9
    v_cvt_pk_bf16_f32 v9, v18, v19
    v_lshlrev_b32 v18, 16, v9
    v_and_b32 v19, 0xffff0000, v9
    v_cvt_pk_bf16_f32 v9, v20, v21
    v_lshlrev_b32 v20, 16, v9
    v_and_b32 v21, 0xffff0000, v9
    v_cvt_pk_bf16_f32 v9, v22, v23
    v_lshlrev_b32 v22, 16, v9
    v_and_b32 v23, 0xffff0000, v9
    v_add_f32 v8, v16, v17
    v_add_f32 v8, v8, v18
    v_add_f32 v8, v8, v19
    v_add_f32 v8, v8, v20
    v_add_f32 v8, v8, v21
    v_add_f32 v8, v8, v22
    v_add_f32 v8, v8, v23
    s_nop 1
    v_add_f32_dpp v8, v8, v8 quad_perm:[1,0,3,2] row_mask:0xf bank_mask:0xf
    s_nop 1
    v_add_f32_dpp v8, v8, v8 quad_perm:[2,3,0,1] row_mask:0xf bank_mask:0xf
    s_nop 1
    v_add_f32_dpp v8, v8, v8 row_half_mirror row_mask:0xf bank_mask:0xf
    s_nop 1
    v_add_f32_dpp v8, v8, v8 row_mirror row_mask:0xf bank_mask:0xf
    v_mov_b32 v9, v8
    s_nop 1
    v_permlane16_swap_b32 v8, v9
    s_nop 0
    v_add_f32 v8, v8, v9
    v_mov_b32 v9, v8
    s_nop 1
    v_permlane32_swap_b32 v8, v9
    s_nop 0
    v_add_f32 v8, v8, v9
    v_mul_f32 v8, 0x3b000000, v8
    v_sub_f32 v9, v16, v8
    v_mul_f32 v10, v9, v9
    v_sub_f32 v9, v17, v8
    v_fmac_f32 v10, v9, v9
    v_sub_f32 v9, v18, v8
    v_fmac_f32 v10, v9, v9
    v_sub_f32 v9, v19, v8
    v_fmac_f32 v10, v9, v9
    v_sub_f32 v9, v20, v8
    v_fmac_f32 v10, v9, v9
    v_sub_f32 v9, v21, v8
    v_fmac_f32 v10, v9, v9
    v_sub_f32 v9, v22, v8
    v_fmac_f32 v10, v9, v9
    v_sub_f32 v9, v23, v8
    v_fmac_f32 v10, v9, v9
    s_nop 1
    v_add_f32_dpp v10, v10, v10 quad_perm:[1,0,3,2] row_mask:0xf bank_mask:0xf
    s_nop 1
    v_add_f32_dpp v10, v10, v10 quad_perm:[2,3,0,1] row_mask:0xf bank_mask:0xf
    s_nop 1
    v_add_f32_dpp v10, v10, v10 row_half_mirror row_mask:0xf bank_mask:0xf
    s_nop 1
    v_add_f32_dpp v10, v10, v10 row_mirror row_mask:0xf bank_mask:0xf
    v_mov_b32 v9, v10
    s_nop 1
    v_permlane16_swap_b32 v10, v9
    s_nop 0
    v_add_f32 v10, v10, v9
    v_mov_b32 v9, v10
    s_nop 1
    v_permlane32_swap_b32 v10, v9
    s_nop 0
    v_add_f32 v10, v10, v9
    v_mul_f32 v10, 0x3b000000, v10
    v_cvt_pk_bf16_f32 v9, v8, v10
    v_lshlrev_b32 v8, 16, v9
    v_and_b32 v10, 0xffff0000, v9
    v_add_f32 v10, 0x3727c5ac, v10
    v_cvt_pk_bf16_f32 v10, v10, v10
    v_lshlrev_b32 v10, 16, v10
    v_sqrt_f32 v10, v10
    s_nop 0
    v_cvt_pk_bf16_f32 v10, v10, v10
    v_lshlrev_b32 v10, 16, v10
    v_rcp_f32 v10, v10
    v_sub_f32 v16, v16, v8
    v_sub_f32 v17, v17, v8
    v_sub_f32 v18, v18, v8
    v_sub_f32 v19, v19, v8
    v_sub_f32 v20, v20, v8
    v_sub_f32 v21, v21, v8
    v_sub_f32 v22, v22, v8
    v_sub_f32 v23, v23, v8
    v_cvt_pk_bf16_f32 v9, v16, v17
    v_lshlrev_b32 v16, 16, v9
    v_and_b32 v17, 0xffff0000, v9
    v_cvt_pk_bf16_f32 v9, v18, v19
    v_lshlrev_b32 v18, 16, v9
    v_and_b32 v19, 0xffff0000, v9
    v_cvt_pk_bf16_f32 v9, v20, v21
    v_lshlrev_b32 v20, 16, v9
    v_and_b32 v21, 0xffff0000, v9
    v_cvt_pk_bf16_f32 v9, v22, v23
    v_lshlrev_b32 v22, 16, v9
    v_and_b32 v23, 0xffff0000, v9
    v_mul_f32 v16, v16, v10
    v_mul_f32 v17, v17, v10
    v_mul_f32 v18, v18, v10
    v_mul_f32 v19, v19, v10
    v_mul_f32 v20, v20, v10
    v_mul_f32 v21, v21, v10
    v_mul_f32 v22, v22, v10
    v_mul_f32 v23, v23, v10
    v_cvt_pk_bf16_f32 v9, v16, v17
    v_lshlrev_b32 v16, 16, v9
    v_and_b32 v17, 0xffff0000, v9
    v_cvt_pk_bf16_f32 v9, v18, v19
    v_lshlrev_b32 v18, 16, v9
    v_and_b32 v19, 0xffff0000, v9
    v_cvt_pk_bf16_f32 v9, v20, v21
    v_lshlrev_b32 v20, 16, v9
    v_and_b32 v21, 0xffff0000, v9
    v_cvt_pk_bf16_f32 v9, v22, v23
    v_lshlrev_b32 v22, 16, v9
    v_and_b32 v23, 0xffff0000, v9
    ds_write_b128 v5, v[16:19] offset:12288
    ds_write_b128 v5, v[20:23] offset:12304
    s_waitcnt lgkmcnt(0)
L_b5b:
    s_barrier
    s_and_b32 s30, s2, 31
    s_lshl_b32 s30, s30, 1
    s_lshr_b32 s31, s24, 2
    s_add_u32 s30, s30, s31
    s_lshl_b32 s30, s30, 5
    v_mov_b32 v5, s30
    ds_read_b128 v[40:43], v5 offset:12288
    ds_read_b128 v[44:47], v5 offset:12304
    v_lshlrev_b32 v224, 16, v224
    v_lshlrev_b32 v232, 16, v232
    v_lshlrev_b32 v240, 16, v240
    v_lshlrev_b32 v225, 16, v225
    v_lshlrev_b32 v233, 16, v233
    v_lshlrev_b32 v241, 16, v241
    v_lshlrev_b32 v226, 16, v226
    v_lshlrev_b32 v234, 16, v234
    v_lshlrev_b32 v242, 16, v242
    v_lshlrev_b32 v227, 16, v227
    v_lshlrev_b32 v235, 16, v235
    v_lshlrev_b32 v243, 16, v243
    v_lshlrev_b32 v228, 16, v228
    v_lshlrev_b32 v236, 16, v236
    v_lshlrev_b32 v244, 16, v244
    v_lshlrev_b32 v229, 16, v229
    v_lshlrev_b32 v237, 16, v237
    v_lshlrev_b32 v245, 16, v245
    v_lshlrev_b32 v230, 16, v230
    v_lshlrev_b32 v238, 16, v238
    v_lshlrev_b32 v246, 16, v246
    s_waitcnt lgkmcnt(0)
    v_mov_b32 v56, 0xc0135761
    v_mov_b32 v57, 0xc0135761
    v_mov_b32 v58, 0xbdd2d3e8
    v_mov_b32 v59, 0xbdd2d3e8
    v_mov_b32 v60, 1.0
    v_mov_b32 v61, 1.0
    v_pk_fma_f32 v[8:9], v[40:41], v[224:225], v[232:233] op_sel:[0,0,0] op_sel_hi:[1,0,0]
    v_pk_mul_f32 v[10:11], v[8:9], v[8:9]
    v_pk_fma_f32 v[10:11], v[10:11], v[58:59], v[56:57]
    v_pk_mul_f32 v[10:11], v[10:11], v[8:9]
    v_pk_mul_f32 v[12:13], v[8:9], v[240:241] op_sel:[0,0] op_sel_hi:[1,0]
    v_exp_f32 v10, v10
    v_exp_f32 v11, v11
    s_nop 0
    v_pk_add_f32 v[10:11], v[10:11], v[60:61]
    v_rcp_f32 v10, v10
    v_rcp_f32 v11, v11
    s_nop 0
    v_pk_mul_f32 v[96:97], v[12:13], v[10:11]
    v_pk_fma_f32 v[14:15], v[42:43], v[224:225], v[232:233] op_sel:[0,0,0] op_sel_hi:[1,0,0]
    v_pk_mul_f32 v[16:17], v[14:15], v[14:15]
    v_pk_fma_f32 v[16:17], v[16:17], v[58:59], v[56:57]
    v_pk_mul_f32 v[16:17], v[16:17], v[14:15]
    v_pk_mul_f32 v[18:19], v[14:15], v[240:241] op_sel:[0,0] op_sel_hi:[1,0]
    v_exp_f32 v16, v16
    v_exp_f32 v17, v17
    s_nop 0
    v_pk_add_f32 v[16:17], v[16:17], v[60:61]
    v_rcp_f32 v16, v16
    v_rcp_f32 v17, v17
    s_nop 0
    v_pk_mul_f32 v[98:99], v[18:19], v[16:17]
    v_pk_fma_f32 v[8:9], v[44:45], v[224:225], v[232:233] op_sel:[0,0,0] op_sel_hi:[1,0,0]
    v_pk_mul_f32 v[10:11], v[8:9], v[8:9]
    v_pk_fma_f32 v[10:11], v[10:11], v[58:59], v[56:57]
    v_pk_mul_f32 v[10:11], v[10:11], v[8:9]
    v_pk_mul_f32 v[12:13], v[8:9], v[240:241] op_sel:[0,0] op_sel_hi:[1,0]
    v_exp_f32 v10, v10
    v_exp_f32 v11, v11
    s_nop 0
    v_pk_add_f32 v[10:11], v[10:11], v[60:61]
    v_rcp_f32 v10, v10
    v_rcp_f32 v11, v11
    s_nop 0
    v_pk_mul_f32 v[100:101], v[12:13], v[10:11]
    v_pk_fma_f32 v[14:15], v[46:47], v[224:225], v[232:233] op_sel:[0,0,0] op_sel_hi:[1,0,0]
    v_pk_mul_f32 v[16:17], v[14:15], v[14:15]
    v_pk_fma_f32 v[16:17], v[16:17], v[58:59], v[56:57]
    v_pk_mul_f32 v[16:17], v[16:17], v[14:15]
    v_pk_mul_f32 v[18:19], v[14:15], v[240:241] op_sel:[0,0] op_sel_hi:[1,0]
    v_exp_f32 v16, v16
    v_exp_f32 v17, v17
    s_nop 0
    v_pk_add_f32 v[16:17], v[16:17], v[60:61]
    v_rcp_f32 v16, v16
    v_rcp_f32 v17, v17
    s_nop 0
    v_pk_mul_f32 v[102:103], v[18:19], v[16:17]
    v_pk_fma_f32 v[8:9], v[40:41], v[224:225], v[232:233] op_sel:[0,1,1] op_sel_hi:[1,1,1]
    v_pk_mul_f32 v[10:11], v[8:9], v[8:9]
    v_pk_fma_f32 v[10:11], v[10:11], v[58:59], v[56:57]
    v_pk_mul_f32 v[10:11], v[10:11], v[8:9]
    v_pk_mul_f32 v[12:13], v[8:9], v[240:241] op_sel:[0,1] op_sel_hi:[1,1]
    v_exp_f32 v10, v10
    v_exp_f32 v11, v11
    s_nop 0
    v_pk_add_f32 v[10:11], v[10:11], v[60:61]
    v_rcp_f32 v10, v10
    v_rcp_f32 v11, v11
    s_nop 0
    v_pk_fma_f32 v[96:97], v[12:13], v[10:11], v[96:97]
    v_pk_fma_f32 v[14:15], v[42:43], v[224:225], v[232:233] op_sel:[0,1,1] op_sel_hi:[1,1,1]
    v_pk_mul_f32 v[16:17], v[14:15], v[14:15]
    v_pk_fma_f32 v[16:17], v[16:17], v[58:59], v[56:57]
    v_pk_mul_f32 v[16:17], v[16:17], v[14:15]
    v_pk_mul_f32 v[18:19], v[14:15], v[240:241] op_sel:[0,1] op_sel_hi:[1,1]
    v_exp_f32 v16, v16
    v_exp_f32 v17, v17
    s_nop 0
    v_pk_add_f32 v[16:17], v[16:17], v[60:61]
    v_rcp_f32 v16, v16
    v_rcp_f32 v17, v17
    s_nop 0
    v_pk_fma_f32 v[98:99], v[18:19], v[16:17], v[98:99]
    v_pk_fma_f32 v[8:9], v[44:45], v[224:225], v[232:233] op_sel:[0,1,1] op_sel_hi:[1,1,1]
    v_pk_mul_f32 v[10:11], v[8:9], v[8:9]
    v_pk_fma_f32 v[10:11], v[10:11], v[58:59], v[56:57]
    v_pk_mul_f32 v[10:11], v[10:11], v[8:9]
    v_pk_mul_f32 v[12:13], v[8:9], v[240:241] op_sel:[0,1] op_sel_hi:[1,1]
    v_exp_f32 v10, v10
    v_exp_f32 v11, v11
    s_nop 0
    v_pk_add_f32 v[10:11], v[10:11], v[60:61]
    v_rcp_f32 v10, v10
    v_rcp_f32 v11, v11
    s_nop 0
    v_pk_fma_f32 v[100:101], v[12:13], v[10:11], v[100:101]
    v_pk_fma_f32 v[14:15], v[46:47], v[224:225], v[232:233] op_sel:[0,1,1] op_sel_hi:[1,1,1]
    v_pk_mul_f32 v[16:17], v[14:15], v[14:15]
    v_pk_fma_f32 v[16:17], v[16:17], v[58:59], v[56:57]
    v_pk_mul_f32 v[16:17], v[16:17], v[14:15]
    v_pk_mul_f32 v[18:19], v[14:15], v[240:241] op_sel:[0,1] op_sel_hi:[1,1]
    v_exp_f32 v16, v16
    v_exp_f32 v17, v17
    s_nop 0
    v_pk_add_f32 v[16:17], v[16:17], v[60:61]
    v_rcp_f32 v16, v16
    v_rcp_f32 v17, v17
    s_nop 0
    v_pk_fma_f32 v[102:103], v[18:19], v[16:17], v[102:103]
    v_pk_fma_f32 v[8:9], v[40:41], v[226:227], v[234:235] op_sel:[0,0,0] op_sel_hi:[1,0,0]
    v_pk_mul_f32 v[10:11], v[8:9], v[8:9]
    v_pk_fma_f32 v[10:11], v[10:11], v[58:59], v[56:57]
    v_pk_mul_f32 v[10:11], v[10:11], v[8:9]
    v_pk_mul_f32 v[12:13], v[8:9], v[242:243] op_sel:[0,0] op_sel_hi:[1,0]
    v_exp_f32 v10, v10
    v_exp_f32 v11, v11
    s_nop 0
    v_pk_add_f32 v[10:11], v[10:11], v[60:61]
    v_rcp_f32 v10, v10
    v_rcp_f32 v11, v11
    s_nop 0
    v_pk_fma_f32 v[96:97], v[12:13], v[10:11], v[96:97]
    v_pk_fma_f32 v[14:15], v[42:43], v[226:227], v[234:235] op_sel:[0,0,0] op_sel_hi:[1,0,0]
    v_pk_mul_f32 v[16:17], v[14:15], v[14:15]
    v_pk_fma_f32 v[16:17], v[16:17], v[58:59], v[56:57]
    v_pk_mul_f32 v[16:17], v[16:17], v[14:15]
    v_pk_mul_f32 v[18:19], v[14:15], v[242:243] op_sel:[0,0] op_sel_hi:[1,0]
    v_exp_f32 v16, v16
    v_exp_f32 v17, v17
    s_nop 0
    v_pk_add_f32 v[16:17], v[16:17], v[60:61]
    v_rcp_f32 v16, v16
    v_rcp_f32 v17, v17
    s_nop 0
    v_pk_fma_f32 v[98:99], v[18:19], v[16:17], v[98:99]
    v_pk_fma_f32 v[8:9], v[44:45], v[226:227], v[234:235] op_sel:[0,0,0] op_sel_hi:[1,0,0]
    v_pk_mul_f32 v[10:11], v[8:9], v[8:9]
    v_pk_fma_f32 v[10:11], v[10:11], v[58:59], v[56:57]
    v_pk_mul_f32 v[10:11], v[10:11], v[8:9]
    v_pk_mul_f32 v[12:13], v[8:9], v[242:243] op_sel:[0,0] op_sel_hi:[1,0]
    v_exp_f32 v10, v10
    v_exp_f32 v11, v11
    s_nop 0
    v_pk_add_f32 v[10:11], v[10:11], v[60:61]
    v_rcp_f32 v10, v10
    v_rcp_f32 v11, v11
    s_nop 0
    v_pk_fma_f32 v[100:101], v[12:13], v[10:11], v[100:101]
    v_pk_fma_f32 v[14:15], v[46:47], v[226:227], v[234:235] op_sel:[0,0,0] op_sel_hi:[1,0,0]
    v_pk_mul_f32 v[16:17], v[14:15], v[14:15]
    v_pk_fma_f32 v[16:17], v[16:17], v[58:59], v[56:57]
    v_pk_mul_f32 v[16:17], v[16:17], v[14:15]
    v_pk_mul_f32 v[18:19], v[14:15], v[242:243] op_sel:[0,0] op_sel_hi:[1,0]
    v_exp_f32 v16, v16
    v_exp_f32 v17, v17
    s_nop 0
    v_pk_add_f32 v[16:17], v[16:17], v[60:61]
    v_rcp_f32 v16, v16
    v_rcp_f32 v17, v17
    s_nop 0
    v_pk_fma_f32 v[102:103], v[18:19], v[16:17], v[102:103]
    v_pk_fma_f32 v[8:9], v[40:41], v[226:227], v[234:235] op_sel:[0,1,1] op_sel_hi:[1,1,1]
    v_pk_mul_f32 v[10:11], v[8:9], v[8:9]
    v_pk_fma_f32 v[10:11], v[10:11], v[58:59], v[56:57]
    v_pk_mul_f32 v[10:11], v[10:11], v[8:9]
    v_pk_mul_f32 v[12:13], v[8:9], v[242:243] op_sel:[0,1] op_sel_hi:[1,1]
    v_exp_f32 v10, v10
    v_exp_f32 v11, v11
    s_nop 0
    v_pk_add_f32 v[10:11], v[10:11], v[60:61]
    v_rcp_f32 v10, v10
    v_rcp_f32 v11, v11
    s_nop 0
    v_pk_fma_f32 v[96:97], v[12:13], v[10:11], v[96:97]
    v_pk_fma_f32 v[14:15], v[42:43], v[226:227], v[234:235] op_sel:[0,1,1] op_sel_hi:[1,1,1]
    v_pk_mul_f32 v[16:17], v[14:15], v[14:15]
    v_pk_fma_f32 v[16:17], v[16:17], v[58:59], v[56:57]
    v_pk_mul_f32 v[16:17], v[16:17], v[14:15]
    v_pk_mul_f32 v[18:19], v[14:15], v[242:243] op_sel:[0,1] op_sel_hi:[1,1]
    v_exp_f32 v16, v16
    v_exp_f32 v17, v17
    s_nop 0
    v_pk_add_f32 v[16:17], v[16:17], v[60:61]
    v_rcp_f32 v16, v16
    v_rcp_f32 v17, v17
    s_nop 0
    v_pk_fma_f32 v[98:99], v[18:19], v[16:17], v[98:99]
    v_pk_fma_f32 v[8:9], v[44:45], v[226:227], v[234:235] op_sel:[0,1,1] op_sel_hi:[1,1,1]
    v_pk_mul_f32 v[10:11], v[8:9], v[8:9]
    v_pk_fma_f32 v[10:11], v[10:11], v[58:59], v[56:57]
    v_pk_mul_f32 v[10:11], v[10:11], v[8:9]
    v_pk_mul_f32 v[12:13], v[8:9], v[242:243] op_sel:[0,1] op_sel_hi:[1,1]
    v_exp_f32 v10, v10
    v_exp_f32 v11, v11
    s_nop 0
    v_pk_add_f32 v[10:11], v[10:11], v[60:61]
    v_rcp_f32 v10, v10
    v_rcp_f32 v11, v11
    s_nop 0
    v_pk_fma_f32 v[100:101], v[12:13], v[10:11], v[100:101]
    v_pk_fma_f32 v[14:15], v[46:47], v[226:227], v[234:235] op_sel:[0,1,1] op_sel_hi:[1,1,1]
    v_pk_mul_f32 v[16:17], v[14:15], v[14:15]
    v_pk_fma_f32 v[16:17], v[16:17], v[58:59], v[56:57]
    v_pk_mul_f32 v[16:17], v[16:17], v[14:15]
    v_pk_mul_f32 v[18:19], v[14:15], v[242:243] op_sel:[0,1] op_sel_hi:[1,1]
    v_exp_f32 v16, v16
    v_exp_f32 v17, v17
    s_nop 0
    v_pk_add_f32 v[16:17], v[16:17], v[60:61]
    v_rcp_f32 v16, v16
    v_rcp_f32 v17, v17
    s_nop 0
    v_pk_fma_f32 v[102:103], v[18:19], v[16:17], v[102:103]
    v_pk_fma_f32 v[8:9], v[40:41], v[228:229], v[236:237] op_sel:[0,0,0] op_sel_hi:[1,0,0]
    v_pk_mul_f32 v[10:11], v[8:9], v[8:9]
    v_pk_fma_f32 v[10:11], v[10:11], v[58:59], v[56:57]
    v_pk_mul_f32 v[10:11], v[10:11], v[8:9]
    v_pk_mul_f32 v[12:13], v[8:9], v[244:245] op_sel:[0,0] op_sel_hi:[1,0]
    v_exp_f32 v10, v10
    v_exp_f32 v11, v11
    s_nop 0
    v_pk_add_f32 v[10:11], v[10:11], v[60:61]
    v_rcp_f32 v10, v10
    v_rcp_f32 v11, v11
    s_nop 0
    v_pk_fma_f32 v[96:97], v[12:13], v[10:11], v[96:97]
    v_pk_fma_f32 v[14:15], v[42:43], v[228:229], v[236:237] op_sel:[0,0,0] op_sel_hi:[1,0,0]
    v_pk_mul_f32 v[16:17], v[14:15], v[14:15]
    v_pk_fma_f32 v[16:17], v[16:17], v[58:59], v[56:57]
    v_pk_mul_f32 v[16:17], v[16:17], v[14:15]
    v_pk_mul_f32 v[18:19], v[14:15], v[244:245] op_sel:[0,0] op_sel_hi:[1,0]
    v_exp_f32 v16, v16
    v_exp_f32 v17, v17
    s_nop 0
    v_pk_add_f32 v[16:17], v[16:17], v[60:61]
    v_rcp_f32 v16, v16
    v_rcp_f32 v17, v17
    s_nop 0
    v_pk_fma_f32 v[98:99], v[18:19], v[16:17], v[98:99]
    v_pk_fma_f32 v[8:9], v[44:45], v[228:229], v[236:237] op_sel:[0,0,0] op_sel_hi:[1,0,0]
    v_pk_mul_f32 v[10:11], v[8:9], v[8:9]
    v_pk_fma_f32 v[10:11], v[10:11], v[58:59], v[56:57]
    v_pk_mul_f32 v[10:11], v[10:11], v[8:9]
    v_pk_mul_f32 v[12:13], v[8:9], v[244:245] op_sel:[0,0] op_sel_hi:[1,0]
    v_exp_f32 v10, v10
    v_exp_f32 v11, v11
    s_nop 0
    v_pk_add_f32 v[10:11], v[10:11], v[60:61]
    v_rcp_f32 v10, v10
    v_rcp_f32 v11, v11
    s_nop 0
    v_pk_fma_f32 v[100:101], v[12:13], v[10:11], v[100:101]
    v_pk_fma_f32 v[14:15], v[46:47], v[228:229], v[236:237] op_sel:[0,0,0] op_sel_hi:[1,0,0]
    v_pk_mul_f32 v[16:17], v[14:15], v[14:15]
    v_pk_fma_f32 v[16:17], v[16:17], v[58:59], v[56:57]
    v_pk_mul_f32 v[16:17], v[16:17], v[14:15]
    v_pk_mul_f32 v[18:19], v[14:15], v[244:245] op_sel:[0,0] op_sel_hi:[1,0]
    v_exp_f32 v16, v16
    v_exp_f32 v17, v17
    s_nop 0
    v_pk_add_f32 v[16:17], v[16:17], v[60:61]
    v_rcp_f32 v16, v16
    v_rcp_f32 v17, v17
    s_nop 0
    v_pk_fma_f32 v[102:103], v[18:19], v[16:17], v[102:103]
    v_pk_fma_f32 v[8:9], v[40:41], v[228:229], v[236:237] op_sel:[0,1,1] op_sel_hi:[1,1,1]
    v_pk_mul_f32 v[10:11], v[8:9], v[8:9]
    v_pk_fma_f32 v[10:11], v[10:11], v[58:59], v[56:57]
    v_pk_mul_f32 v[10:11], v[10:11], v[8:9]
    v_pk_mul_f32 v[12:13], v[8:9], v[244:245] op_sel:[0,1] op_sel_hi:[1,1]
    v_exp_f32 v10, v10
    v_exp_f32 v11, v11
    s_nop 0
    v_pk_add_f32 v[10:11], v[10:11], v[60:61]
    v_rcp_f32 v10, v10
    v_rcp_f32 v11, v11
    s_nop 0
    v_pk_fma_f32 v[96:97], v[12:13], v[10:11], v[96:97]
    v_pk_fma_f32 v[14:15], v[42:43], v[228:229], v[236:237] op_sel:[0,1,1] op_sel_hi:[1,1,1]
    v_pk_mul_f32 v[16:17], v[14:15], v[14:15]
    v_pk_fma_f32 v[16:17], v[16:17], v[58:59], v[56:57]
    v_pk_mul_f32 v[16:17], v[16:17], v[14:15]
    v_pk_mul_f32 v[18:19], v[14:15], v[244:245] op_sel:[0,1] op_sel_hi:[1,1]
    v_exp_f32 v16, v16
    v_exp_f32 v17, v17
    s_nop 0
    v_pk_add_f32 v[16:17], v[16:17], v[60:61]
    v_rcp_f32 v16, v16
    v_rcp_f32 v17, v17
    s_nop 0
    v_pk_fma_f32 v[98:99], v[18:19], v[16:17], v[98:99]
    v_pk_fma_f32 v[8:9], v[44:45], v[228:229], v[236:237] op_sel:[0,1,1] op_sel_hi:[1,1,1]
    v_pk_mul_f32 v[10:11], v[8:9], v[8:9]
    v_pk_fma_f32 v[10:11], v[10:11], v[58:59], v[56:57]
    v_pk_mul_f32 v[10:11], v[10:11], v[8:9]
    v_pk_mul_f32 v[12:13], v[8:9], v[244:245] op_sel:[0,1] op_sel_hi:[1,1]
    v_exp_f32 v10, v10
    v_exp_f32 v11, v11
    s_nop 0
    v_pk_add_f32 v[10:11], v[10:11], v[60:61]
    v_rcp_f32 v10, v10
    v_rcp_f32 v11, v11
    s_nop 0
    v_pk_fma_f32 v[100:101], v[12:13], v[10:11], v[100:101]
    v_pk_fma_f32 v[14:15], v[46:47], v[228:229], v[236:237] op_sel:[0,1,1] op_sel_hi:[1,1,1]
    v_pk_mul_f32 v[16:17], v[14:15], v[14:15]
    v_pk_fma_f32 v[16:17], v[16:17], v[58:59], v[56:57]
    v_pk_mul_f32 v[16:17], v[16:17], v[14:15]
    v_pk_mul_f32 v[18:19], v[14:15], v[244:245] op_sel:[0,1] op_sel_hi:[1,1]
    v_exp_f32 v16, v16
    v_exp_f32 v17, v17
    s_nop 0
    v_pk_add_f32 v[16:17], v[16:17], v[60:61]
    v_rcp_f32 v16, v16
    v_rcp_f32 v17, v17
    s_nop 0
    v_pk_fma_f32 v[102:103], v[18:19], v[16:17], v[102:103]
    v_pk_fma_f32 v[8:9], v[40:41], v[230:231], v[238:239] op_sel:[0,0,0] op_sel_hi:[1,0,0]
    v_pk_mul_f32 v[10:11], v[8:9], v[8:9]
    v_pk_fma_f32 v[10:11], v[10:11], v[58:59], v[56:57]
    v_pk_mul_f32 v[10:11], v[10:11], v[8:9]
    v_pk_mul_f32 v[12:13], v[8:9], v[246:247] op_sel:[0,0] op_sel_hi:[1,0]
    v_exp_f32 v10, v10
    v_exp_f32 v11, v11
    s_nop 0
    v_pk_add_f32 v[10:11], v[10:11], v[60:61]
    v_rcp_f32 v10, v10
    v_rcp_f32 v11, v11
    s_nop 0
    v_pk_fma_f32 v[96:97], v[12:13], v[10:11], v[96:97]
    v_pk_fma_f32 v[14:15], v[42:43], v[230:231], v[238:239] op_sel:[0,0,0] op_sel_hi:[1,0,0]
    v_pk_mul_f32 v[16:17], v[14:15], v[14:15]
    v_pk_fma_f32 v[16:17], v[16:17], v[58:59], v[56:57]
    v_pk_mul_f32 v[16:17], v[16:17], v[14:15]
    v_pk_mul_f32 v[18:19], v[14:15], v[246:247] op_sel:[0,0] op_sel_hi:[1,0]
    v_exp_f32 v16, v16
    v_exp_f32 v17, v17
    s_nop 0
    v_pk_add_f32 v[16:17], v[16:17], v[60:61]
    v_rcp_f32 v16, v16
    v_rcp_f32 v17, v17
    s_nop 0
    v_pk_fma_f32 v[98:99], v[18:19], v[16:17], v[98:99]
    v_pk_fma_f32 v[8:9], v[44:45], v[230:231], v[238:239] op_sel:[0,0,0] op_sel_hi:[1,0,0]
    v_pk_mul_f32 v[10:11], v[8:9], v[8:9]
    v_pk_fma_f32 v[10:11], v[10:11], v[58:59], v[56:57]
    v_pk_mul_f32 v[10:11], v[10:11], v[8:9]
    v_pk_mul_f32 v[12:13], v[8:9], v[246:247] op_sel:[0,0] op_sel_hi:[1,0]
    v_exp_f32 v10, v10
    v_exp_f32 v11, v11
    s_nop 0
    v_pk_add_f32 v[10:11], v[10:11], v[60:61]
    v_rcp_f32 v10, v10
    v_rcp_f32 v11, v11
    s_nop 0
    v_pk_fma_f32 v[100:101], v[12:13], v[10:11], v[100:101]
    v_pk_fma_f32 v[14:15], v[46:47], v[230:231], v[238:239] op_sel:[0,0,0] op_sel_hi:[1,0,0]
    v_pk_mul_f32 v[16:17], v[14:15], v[14:15]
    v_pk_fma_f32 v[16:17], v[16:17], v[58:59], v[56:57]
    v_pk_mul_f32 v[16:17], v[16:17], v[14:15]
    v_pk_mul_f32 v[18:19], v[14:15], v[246:247] op_sel:[0,0] op_sel_hi:[1,0]
    v_exp_f32 v16, v16
    v_exp_f32 v17, v17
    s_nop 0
    v_pk_add_f32 v[16:17], v[16:17], v[60:61]
    v_rcp_f32 v16, v16
    v_rcp_f32 v17, v17
    s_nop 0
    v_pk_fma_f32 v[102:103], v[18:19], v[16:17], v[102:103]
    s_nop 1
    v_add_f32_dpp v96, v96, v96 quad_perm:[1,0,3,2] row_mask:0xf bank_mask:0xf
    v_add_f32_dpp v97, v97, v97 quad_perm:[1,0,3,2] row_mask:0xf bank_mask:0xf
    v_add_f32_dpp v98, v98, v98 quad_perm:[1,0,3,2] row_mask:0xf bank_mask:0xf
    v_add_f32_dpp v99, v99, v99 quad_perm:[1,0,3,2] row_mask:0xf bank_mask:0xf
    v_add_f32_dpp v100, v100, v100 quad_perm:[1,0,3,2] row_mask:0xf bank_mask:0xf
    v_add_f32_dpp v101, v101, v101 quad_perm:[1,0,3,2] row_mask:0xf bank_mask:0xf
    v_add_f32_dpp v102, v102, v102 quad_perm:[1,0,3,2] row_mask:0xf bank_mask:0xf
    v_add_f32_dpp v103, v103, v103 quad_perm:[1,0,3,2] row_mask:0xf bank_mask:0xf
    v_add_f32_dpp v96, v96, v96 quad_perm:[2,3,0,1] row_mask:0xf bank_mask:0xf
    v_add_f32_dpp v97, v97, v97 quad_perm:[2,3,0,1] row_mask:0xf bank_mask:0xf
    v_add_f32_dpp v98, v98, v98 quad_perm:[2,3,0,1] row_mask:0xf bank_mask:0xf
    v_add_f32_dpp v99, v99, v99 quad_perm:[2,3,0,1] row_mask:0xf bank_mask:0xf
    v_add_f32_dpp v100, v100, v100 quad_perm:[2,3,0,1] row_mask:0xf bank_mask:0xf
    v_add_f32_dpp v101, v101, v101 quad_perm:[2,3,0,1] row_mask:0xf bank_mask:0xf
    v_add_f32_dpp v102, v102, v102 quad_perm:[2,3,0,1] row_mask:0xf bank_mask:0xf
    v_add_f32_dpp v103, v103, v103 quad_perm:[2,3,0,1] row_mask:0xf bank_mask:0xf
    v_add_f32_dpp v96, v96, v96 row_half_mirror row_mask:0xf bank_mask:0xf
    v_add_f32_dpp v97, v97, v97 row_half_mirror row_mask:0xf bank_mask:0xf
    v_add_f32_dpp v98, v98, v98 row_half_mirror row_mask:0xf bank_mask:0xf
    v_add_f32_dpp v99, v99, v99 row_half_mirror row_mask:0xf bank_mask:0xf
    v_add_f32_dpp v100, v100, v100 row_half_mirror row_mask:0xf bank_mask:0xf
    v_add_f32_dpp v101, v101, v101 row_half_mirror row_mask:0xf bank_mask:0xf
    v_add_f32_dpp v102, v102, v102 row_half_mirror row_mask:0xf bank_mask:0xf
    v_add_f32_dpp v103, v103, v103 row_half_mirror row_mask:0xf bank_mask:0xf
    v_add_f32_dpp v96, v96, v96 row_mirror row_mask:0xf bank_mask:0xf
    v_add_f32_dpp v97, v97, v97 row_mirror row_mask:0xf bank_mask:0xf
    v_add_f32_dpp v98, v98, v98 row_mirror row_mask:0xf bank_mask:0xf
    v_add_f32_dpp v99, v99, v99 row_mirror row_mask:0xf bank_mask:0xf
    v_add_f32_dpp v100, v100, v100 row_mirror row_mask:0xf bank_mask:0xf
    v_add_f32_dpp v101, v101, v101 row_mirror row_mask:0xf bank_mask:0xf
    v_add_f32_dpp v102, v102, v102 row_mirror row_mask:0xf bank_mask:0xf
    v_add_f32_dpp v103, v103, v103 row_mirror row_mask:0xf bank_mask:0xf
    v_lshrrev_b32 v8, 4, v0
    v_lshlrev_b32 v8, 5, v8
    v_cmp_eq_u32 vcc, 0, v4
    s_and_saveexec_b64 s[34:35], vcc
    ds_write_b128 v8, v[96:99] offset:16384
    ds_write_b128 v8, v[100:103] offset:16400
    s_mov_b64 exec, s[34:35]
    s_waitcnt lgkmcnt(0)
    s_barrier
    v_cmp_gt_u32 vcc, 16, v0
    s_and_saveexec_b64 s[34:35], vcc
    s_cbranch_execz L_done
    v_lshrrev_b32 v8, 3, v0
    v_lshlrev_b32 v8, 9, v8
    v_and_b32 v9, 7, v0
    v_lshl_add_u32 v8, v9, 2, v8
    ds_read_b32 v16, v8 offset:16384
    ds_read_b32 v17, v8 offset:16416
    ds_read_b32 v18, v8 offset:16448
    ds_read_b32 v19, v8 offset:16480
    ds_read_b32 v20, v8 offset:16512
    ds_read_b32 v21, v8 offset:16544
    ds_read_b32 v22, v8 offset:16576
    ds_read_b32 v23, v8 offset:16608
    ds_read_b32 v24, v8 offset:16640
    ds_read_b32 v25, v8 offset:16672
    ds_read_b32 v26, v8 offset:16704
    ds_read_b32 v27, v8 offset:16736
    ds_read_b32 v28, v8 offset:16768
    ds_read_b32 v29, v8 offset:16800
    ds_read_b32 v30, v8 offset:16832
    ds_read_b32 v31, v8 offset:16864
    s_and_b32 s30, s2, 31
    s_lshl_b32 s30, s30, 6
    v_lshlrev_b32 v9, 2, v0
    v_add_u32 v9, s30, v9
    ds_read_b32 v10, v9 offset:8192
    s_waitcnt lgkmcnt(0)
    v_add_f32 v16, v16, v17
    v_add_f32 v16, v16, v18
    v_add_f32 v16, v16, v19
    v_add_f32 v16, v16, v20
    v_add_f32 v16, v16, v21
    v_add_f32 v16, v16, v22
    v_add_f32 v16, v16, v23
    v_add_f32 v16, v16, v24
    v_add_f32 v16, v16, v25
    v_add_f32 v16, v16, v26
    v_add_f32 v16, v16, v27
    v_add_f32 v16, v16, v28
    v_add_f32 v16, v16, v29
    v_add_f32 v16, v16, v30
    v_add_f32 v16, v16, v31
    v_cvt_pk_bf16_f32 v16, v16, v16
    v_lshlrev_b32 v16, 16, v16
    v_lshlrev_b32 v254, 16, v254
    v_add_f32 v16, v16, v254
    v_cvt_pk_bf16_f32 v16, v16, v16
    v_lshlrev_b32 v16, 16, v16
    v_add_f32 v16, v16, v10
    v_cvt_pk_bf16_f32 v16, v16, v16
    v_lshlrev_b32 v8, 1, v0
    s_lshr_b32 s30, s30, 1
    s_lshl_b32 s31, s26, 10
    s_add_u32 s30, s30, s31
    buffer_store_short v16, v8, s[72:75], s30 offen
L_done:
    s_endpgm
.section .rodata,"a"
.p2align 6
.amdhsa_kernel sequential_preLN__gqa_block_cached__mixer_token_mlp__decode_kernel
  .amdhsa_next_free_vgpr 256
  .amdhsa_next_free_sgpr 102
  .amdhsa_accum_offset 256
  .amdhsa_group_segment_fixed_size 0
  .amdhsa_kernarg_size 104
  .amdhsa_user_sgpr_count 2
  .amdhsa_user_sgpr_kernarg_segment_ptr 1
  .amdhsa_system_sgpr_workgroup_id_x 1
.end_amdhsa_kernel
```
